```python
import torch

def _softmax(x, axis=-1):
    return torch.softmax(x, dim=axis)
def _gelu(x):
    return torch.nn.functional.gelu(x, approximate="tanh")
def _silu(x):
    return torch.nn.functional.silu(x)
def _sigmoid(x):
    return torch.sigmoid(x)
def _layernorm(x, axis=-1, eps=1e-5):
    m = x.mean(dim=axis, keepdim=True)
    v = x.var(dim=axis, keepdim=True, unbiased=False)
    return (x - m) / torch.sqrt(v + eps)
def _scatter_add(tgt, idx, src, axis=0):
    return tgt.clone().index_add_(axis, idx, src)
def _segment_sum(src, seg, n):
    out = torch.zeros((n,) + src.shape[1:], dtype=src.dtype)
    return out.index_add_(0, seg, src)
def _pad(x, pw):
    flat = tuple(v for pair in reversed(pw) for v in pair)
    return torch.nn.functional.pad(x, flat)

kernel_name = 'gated_mix__ssm_conv_s4d__ssm_conv_s4d__prompt'

def setup_inputs():

    _w = (lambda a: (lambda t: t.to(torch.bfloat16) if t.is_floating_point() else t)(torch.as_tensor(a)))
    def _A_setup():
        Bsz, L, D, N = 1, 2048, 512, 128
        return {
            "u": _w((lambda *s: torch.randn(*s, dtype=torch.bfloat16) * 0.05)(Bsz, L, D)),
            "log_A_real": _w((lambda *s: torch.randn(*s, dtype=torch.bfloat16) * 6.4)(D, N) * 0.5),
            "A_imag": _w((lambda *s: torch.randn(*s, dtype=torch.bfloat16) * 0.05)(D, N) * 3.14),
            "C_real": _w((lambda *s: torch.randn(*s, dtype=torch.bfloat16) * 0.05)(D, N) / N ** 0.5),
            "C_imag": _w((lambda *s: torch.randn(*s, dtype=torch.bfloat16) * 0.05)(D, N) / N ** 0.5),
            "log_dt": _w((lambda *s: torch.randn(*s, dtype=torch.bfloat16) * 0.05)(D) * 0.5 - 4.0),
            "D_skip": _w((lambda *s: torch.randn(*s, dtype=torch.bfloat16) * 0.05)(D)),
        }
    _A_in = _A_setup()

    def _B_setup():
        Bsz, L, D, N = 1, 2048, 512, 128
        return {
            "u": _w((lambda *s: torch.randn(*s, dtype=torch.bfloat16) * 0.05)(Bsz, L, D)),
            "log_A_real": _w((lambda *s: torch.randn(*s, dtype=torch.bfloat16) * 6.4)(D, N) * 0.5),
            "A_imag": _w((lambda *s: torch.randn(*s, dtype=torch.bfloat16) * 0.05)(D, N) * 3.14),
            "C_real": _w((lambda *s: torch.randn(*s, dtype=torch.bfloat16) * 0.05)(D, N) / N ** 0.5),
            "C_imag": _w((lambda *s: torch.randn(*s, dtype=torch.bfloat16) * 0.05)(D, N) / N ** 0.5),
            "log_dt": _w((lambda *s: torch.randn(*s, dtype=torch.bfloat16) * 0.05)(D) * 0.5 - 4.0),
            "D_skip": _w((lambda *s: torch.randn(*s, dtype=torch.bfloat16) * 0.05)(D)),
        }
    _B_in = _B_setup()

    return {
        "A_u": _A_in["u"],
        "A_log_A_real": _A_in["log_A_real"],
        "A_A_imag": _A_in["A_imag"],
        "A_C_real": _A_in["C_real"],
        "A_C_imag": _A_in["C_imag"],
        "A_log_dt": _A_in["log_dt"],
        "A_D_skip": _A_in["D_skip"],
        "B_u": _B_in["u"],
        "B_log_A_real": _B_in["log_A_real"],
        "B_A_imag": _B_in["A_imag"],
        "B_C_real": _B_in["C_real"],
        "B_C_imag": _B_in["C_imag"],
        "B_log_dt": _B_in["log_dt"],
        "B_D_skip": _B_in["D_skip"],
        "gate_w": _w((lambda *s: torch.randn(*s, dtype=torch.bfloat16) * 0.05)(512) * 16.0),
    }

def reference(A_u, A_log_A_real, A_A_imag, A_C_real, A_C_imag, A_log_dt, A_D_skip, B_u, B_log_A_real, B_A_imag, B_C_real, B_C_imag, B_log_dt, B_D_skip, gate_w):
    def _A_ref(u, log_A_real, A_imag, C_real, C_imag, log_dt, D_skip):
        L = u.shape[1]
        dt = torch.exp(log_dt)
        A = -torch.exp(log_A_real) + 1j * A_imag
        C = (C_real + 1j * C_imag) * dt[:, None]
        pos = (lambda x, dt: x.to(dt))(torch.arange(L), log_dt.dtype)
        P = torch.exp((A * dt[:, None])[:, :, None] * pos[None, None, :])
        K = 2.0 * torch.einsum("dn,dnl->dl", C, P).real
        L2 = 2 * L
        u_t = (lambda x, *d: x.permute(*d))(u, 0, 2, 1)
        Kf = (lambda x, *a, **k: torch.fft.rfft(x.float(), *a, **k))(K, L2)
        Uf = (lambda x, *a, **k: torch.fft.rfft(x.float(), *a, **k))(u_t, L2)
        y = (lambda x, *a, **k: torch.fft.irfft(x, *a, **k).to(torch.bfloat16))(Uf * Kf[None, :, :], L2)[:, :, :L]
        y = (lambda x, *d: x.permute(*d))(y, 0, 2, 1)
        return y + u * D_skip[None, None, :]

    def _B_ref(u, log_A_real, A_imag, C_real, C_imag, log_dt, D_skip):
        L = u.shape[1]
        dt = torch.exp(log_dt)
        A = -torch.exp(log_A_real) + 1j * A_imag
        C = (C_real + 1j * C_imag) * dt[:, None]
        pos = (lambda x, dt: x.to(dt))(torch.arange(L), log_dt.dtype)
        P = torch.exp((A * dt[:, None])[:, :, None] * pos[None, None, :])
        K = 2.0 * torch.einsum("dn,dnl->dl", C, P).real
        L2 = 2 * L
        u_t = (lambda x, *d: x.permute(*d))(u, 0, 2, 1)
        Kf = (lambda x, *a, **k: torch.fft.rfft(x.float(), *a, **k))(K, L2)
        Uf = (lambda x, *a, **k: torch.fft.rfft(x.float(), *a, **k))(u_t, L2)
        y = (lambda x, *a, **k: torch.fft.irfft(x, *a, **k).to(torch.bfloat16))(Uf * Kf[None, :, :], L2)[:, :, :L]
        y = (lambda x, *d: x.permute(*d))(y, 0, 2, 1)
        return y + u * D_skip[None, None, :]

    x = A_u
    g = _sigmoid((x * gate_w).sum(-1, keepdims=True))
    a = _A_ref(x, A_log_A_real, A_A_imag, A_C_real, A_C_imag, A_log_dt, A_D_skip)
    b = _B_ref(x, B_log_A_real, B_A_imag, B_C_real, B_C_imag, B_log_dt, B_D_skip)
    return g * a + (1 - g) * b
```

```asm
; @launch grid=(256,1,1) block=(512,1,1) lds=138384
.amdgcn_target "amdgcn-amd-amdhsa--gfx950"
.text
.globl gated_mix__ssm_conv_s4d__ssm_conv_s4d__prompt_kernel
.p2align 8
.type gated_mix__ssm_conv_s4d__ssm_conv_s4d__prompt_kernel,@function
gated_mix__ssm_conv_s4d__ssm_conv_s4d__prompt_kernel:
    s_cmp_ge_u32 s2, 256
    s_cbranch_scc1 L_end
    s_load_dwordx2 s[4:5], s[0:1], 0
    s_load_dwordx8 s[20:27], s[0:1], 112
    v_lshrrev_b32 v2, 6, v0
    v_and_b32 v1, 63, v0
    s_getpc_b64 s[44:45]
L_pc:
    v_readfirstlane_b32 s3, v2
    s_and_b32 s55, s2, 7
    s_lshr_b32 s58, s2, 3
    s_lshl_b32 s59, s55, 7
    s_lshl_b32 s62, s58, 2
    s_add_u32 s62, s62, s59
    s_bfe_u32 s47, s3, 0x10001
    s_mul_i32 s6, s47, 56
    s_add_u32 s7, s6, 40
    s_add_u32 s6, s6, 8
    s_load_dwordx8 s[8:15], s[0:1], s6
    s_load_dwordx4 s[16:19], s[0:1], s7
    s_cmp_lg_u32 s3, 0
    s_cbranch_scc1 L_nocp
    s_and_b32 s6, s58, 3
    s_lshl_b32 s6, s6, 12
    v_lshl_add_u32 v3, v1, 6, s6
    v_min_u32 v3, L_codeend-L_pc-4, v3
    v_mov_b32 v5, s45
    v_add_co_u32 v4, vcc, s44, v3
    s_nop 1
    v_addc_co_u32_e64 v5, vcc, 0, v5, vcc
    global_load_dword v127, v[4:5], off
L_nocp:
    s_and_b32 s40, s3, 3
    s_and_b32 s41, s40, 1
    s_lshr_b32 s6, s62, 1
    s_add_u32 s6, s6, s41
    s_lshl_b32 s6, s6, 8
    s_lshr_b32 s7, s3, 2
    s_lshl_b32 s56, s7, 7
    s_add_u32 s6, s6, s56
    v_lshl_add_u32 v8, v1, 1, s6
    s_lshl_b32 s63, s40, 9
    s_lshl_b32 s7, s7, 8
    s_add_u32 s63, s63, s7
    v_mov_b32 v10, 0
    v_mov_b32 v11, 0
    v_mov_b32 v12, 0
    v_mov_b32_e64 v13, 0
    s_mov_b32 m0, s63
    s_waitcnt lgkmcnt(0)
    global_load_short_d16_hi v10, v8, s[8:9]
    global_load_short_d16_hi v11, v8, s[10:11]
    global_load_short_d16_hi v12, v8, s[12:13]
    global_load_short_d16_hi v13, v8, s[14:15]
    s_load_dword s50, s[16:17], s62
    s_barrier
    s_cmp_ge_u32 s3, 4
    s_cbranch_scc1 L_hearly
    v_lshrrev_b32 v2, 5, v0
    v_and_b32 v3, 31, v0
    v_lshlrev_b32 v3, 4, v3
    s_and_b32 s6, s2, 7
    s_lshl_b32 s6, s6, 18
    s_lshl_b32 s7, s58, 13
    s_add_u32 s6, s6, s7
    v_lshl_add_u32 v2, v2, 10, s6
    v_add_u32_e64 v2, v2, v3
    global_load_dwordx4 v[76:79], v2, s[4:5]
    global_load_dwordx4 v[80:83], v2, s[4:5] offset:512
    global_load_dwordx4 v[84:87], v3, s[20:21]
    global_load_dwordx4 v[88:91], v3, s[20:21] offset:512
    v_mov_b32 v9, 8192
    global_load_dword v9, v9, s[26:27]
    v_lshrrev_b32 v2, 3, v1
    v_and_b32 v3, 7, v1
    s_lshl_b32 s56, s58, 15
    s_add_u32 s56, s56, s59
    s_lshl_b32 s7, s40, 5
    s_add_u32 s7, s7, s56
    s_add_u32 s7, s7, 0x100000
    v_lshlrev_b32_e64 v4, 11, v2
    v_lshl_add_u32 v4, v3, 2, v4
    v_add_u32_e64 v4, s7, v4
    v_add_u32 v5, 0x4000, v4
    global_load_dword v92, v4, s[4:5]
    global_load_dword v93, v4, s[4:5] offset:1024
    global_load_dword v94, v5, s[4:5]
    global_load_dword v95, v5, s[4:5] offset:1024
    v_lshlrev_b32_e64 v104, 5, v3
    v_lshl_add_u32 v104, v2, 2, v104
    s_lshl_b32 s56, s55, 5
    s_lshl_b32 s7, s40, 3
    s_add_u32 s7, s7, s56
    s_lshl_b32 s7, s7, 13
    s_lshl_b32 s56, s58, 8
    s_add_u32 s7, s7, s56
    s_add_u32 s7, s7, 16384
    v_lshlrev_b32_e64 v4, 13, v2
    v_lshl_add_u32 v4, v3, 4, v4
    v_add_u32_e64 v105, s7, v4
    s_add_u32 s44, s44, L_wtab+4096-L_pc
    s_addc_u32 s45, s45, 0
    v_lshlrev_b32 v3, 4, v1
    v_mov_b32 v125, s45
    v_add_co_u32 v124, vcc, s44, v3
    s_nop 1
    v_addc_co_u32 v125, vcc, 0, v125, vcc
    global_load_dwordx4 v[42:45], v[124:125], off
    global_load_dwordx4 v[46:49], v[124:125], off offset:1024
    global_load_dwordx4 v[50:53], v[124:125], off offset:2048
    global_load_dwordx2 v[54:55], v[124:125], off offset:3072
    s_branch L_mrest
L_hearly:
    v_add_u32 v42, 0xffffff00, v0
    v_and_b32 v3, 7, v1
    s_lshl_b32 s6, s58, 15
    s_add_u32 s6, s6, s59
    v_lshrrev_b32_e64 v6, 3, v42
    v_lshl_add_u32 v6, v6, 10, s6
    v_lshl_add_u32 v6, v3, 4, v6
    global_load_dwordx4 v[64:67], v6, s[4:5]
    s_mov_b32 s28, s4
    s_mov_b32 s29, s5
    s_mov_b32 s30, 2097152
    s_mov_b32 s31, 0x20000
    s_mov_b32 s42, 0x80000
    s_mov_b32 s8, 0x05040100
    s_mov_b32 s9, 0x07060302
    v_lshlrev_b32_e64 v43, 2, v42
    v_add_u32 v43, 111488, v43
    v_lshl_add_u32 v45, v42, 11, s62
    v_lshlrev_b32_e64 v8, 4, v42
    v_add_u32 v8, 128128, v8
    v_mov_b32 v4, 0
    v_mov_b32 v5, 0
    v_mov_b32 v6, 0
    v_mov_b32 v7, 0
    ds_write_b128 v8, v[4:7]
    ds_write_b128 v8, v[4:7] offset:4096
    s_cmp_ge_u32 s40, 2
    s_cbranch_scc1 L_nozero
    ds_write_b128 v8, v[4:7] offset:8192
    s_cmp_lg_u32 s40, 0
    s_cbranch_scc1 L_nozero
    v_lshrrev_b32_e64 v6, 4, v1
    v_mul_u32_u24 v6, 4160, v6
    v_and_b32_e64 v2, 15, v1
    v_lshl_add_u32 v6, v2, 2, v6
    v_add_u32 v6, 111488, v6
    ds_write_b32 v6, v7
L_nozero:
    v_mov_b32 v6, 0x3f80
    ds_write_addtid_b32 v6
    s_lshl_b32 s56, s41, 4
    s_waitcnt lgkmcnt(0)
    s_lshr_b32 s50, s50, s56
    s_lshl_b32 s50, s50, 16
    v_mov_b32_e64 v14, s50
    v_mul_f32 v14, 0x3fb8aa3b, v14
    v_exp_f32 v14, v14
    s_nop 0
    v_cvt_pk_bf16_f32 v14, v14, v14
    v_and_b32 v14, 0xffff0000, v14
    v_mul_f32 v15, 0xbfb8aa3b, v14
    v_mul_f32 v16, 0.15915494, v14
    v_add_f32_e64 v17, v14, v14
    s_waitcnt vmcnt(4)
    v_mul_f32 v10, 0x3fb8aa3b, v10
    v_exp_f32 v10, v10
    s_waitcnt vmcnt(3)
    v_mul_f32_e64 v11, v11, v16
    v_mul_f32 v39, 0x41000000, v11
    v_cvt_pk_bf16_f32 v10, v10, v10
    v_rndne_f32_e64 v40, v39
    v_and_b32 v10, 0xffff0000, v10
    v_sub_f32 v39, v39, v40
    v_mul_f32 v10, v10, v15
    v_cos_f32_e64 v20, v39
    v_mul_f32 v37, 0x41000000, v10
    v_sin_f32 v21, v39
    v_rndne_f32 v40, v11
    v_exp_f32 v37, v37
    v_sub_f32 v38, v11, v40
    v_exp_f32 v36, v10
    v_mul_f32 v20, v20, v37
    v_mul_f32 v21, v21, v37
    v_cos_f32 v18, v38
    s_waitcnt vmcnt(2)
    v_mul_f32 v24, v12, v17
    v_sin_f32 v19, v38
    s_waitcnt vmcnt(1)
    v_mul_f32 v25, v13, v17
    v_mul_f32 v18, v18, v36
    v_mul_f32_e64 v19, v19, v36
    s_mov_b32 s51, 1
    s_branch L_shared
L_mrest:
    s_mov_b32 s36, s26
    s_mov_b32 s37, s27
    s_mov_b32 s38, 4210688
    s_mov_b32 s39, 0x20000
    s_mov_b32 s54, 0
    s_lshr_b32 s56, s6, 8
    s_lshl_b32 s57, s40, 3
    s_add_u32 s56, s56, s57
    v_mov_b32_e64 v59, s56
    s_mov_b32 s42, 0x9E3779B1
    v_mov_b32 v106, 138368
    v_mov_b32 v6, 0x3f80
    ds_write_addtid_b32 v6
    s_lshl_b32 s56, s41, 4
    s_waitcnt lgkmcnt(0)
    s_load_dword s49, s[18:19], s62
    s_lshr_b32 s50, s50, s56
    s_lshl_b32 s50, s50, 16
    v_mov_b32_e64 v14, s50
    v_mul_f32 v14, 0x3fb8aa3b, v14
    v_exp_f32 v14, v14
    s_nop 0
    v_cvt_pk_bf16_f32 v14, v14, v14
    v_and_b32 v14, 0xffff0000, v14
    v_mul_f32 v15, 0xbfb8aa3b, v14
    v_mul_f32 v16, 0.15915494, v14
    v_add_f32_e64 v17, v14, v14
    s_waitcnt vmcnt(16)
    v_mul_f32 v10, 0x3fb8aa3b, v10
    v_exp_f32 v10, v10
    s_waitcnt vmcnt(15)
    v_mul_f32_e64 v11, v11, v16
    v_mul_f32 v39, 0x41000000, v11
    v_cvt_pk_bf16_f32 v10, v10, v10
    v_rndne_f32_e64 v40, v39
    v_and_b32 v10, 0xffff0000, v10
    v_sub_f32 v39, v39, v40
    v_mul_f32 v10, v10, v15
    v_cos_f32_e64 v20, v39
    v_mul_f32 v37, 0x41000000, v10
    v_sin_f32 v21, v39
    v_rndne_f32 v40, v11
    v_exp_f32 v37, v37
    v_sub_f32 v38, v11, v40
    v_exp_f32 v36, v10
    v_mul_f32 v20, v20, v37
    v_mul_f32 v21, v21, v37
    v_cos_f32 v18, v38
    s_waitcnt vmcnt(14)
    v_mul_f32 v24, v12, v17
    v_sin_f32 v19, v38
    s_waitcnt vmcnt(13)
    v_mul_f32 v25, v13, v17
    v_mul_f32 v18, v18, v36
    v_mul_f32 v19, v19, v36
    s_mov_b32 s51, 0
L_shared:
    v_pk_mul_f32 v[6:7], v[20:21], v[20:21] op_sel_hi:[1,0]
    v_pk_fma_f32 v[28:29], v[20:21], v[20:21], v[6:7] op_sel:[1,1,0] op_sel_hi:[0,1,1] neg_lo:[1,0,0]
    v_cvt_pk_bf16_f32 v32, v20, -v21
    v_cvt_pk_bf16_f32 v33, v28, -v29
    ds_write_addtid_b32 v32 offset:2064
    ds_write_addtid_b32 v33 offset:4128
    v_pk_mul_f32 v[30:31], v[20:21], v[28:29] op_sel_hi:[1,0]
    v_pk_mul_f32 v[6:7], v[28:29], v[28:29] op_sel_hi:[1,0]
    v_pk_fma_f32 v[22:23], v[20:21], v[28:29], v[30:31] op_sel:[1,1,0] op_sel_hi:[0,1,1] neg_lo:[1,0,0]
    v_pk_fma_f32 v[4:5], v[28:29], v[28:29], v[6:7] op_sel:[1,1,0] op_sel_hi:[0,1,1] neg_lo:[1,0,0]
    v_cvt_pk_bf16_f32 v34, v22, -v23
    v_cvt_pk_bf16_f32 v35, v4, -v5
    ds_write_addtid_b32 v34 offset:6192
    ds_write_addtid_b32 v35 offset:8256
    s_cmp_lg_u32 s51, 0
    s_cbranch_scc1 L_sj15
    global_load_dwordx4 v[60:63], v[124:125], off offset:-4096
    global_load_dwordx4 v[64:67], v[124:125], off offset:-3072
    global_load_dwordx4 v[68:71], v[124:125], off offset:-2048
    global_load_dwordx4 v[72:75], v[124:125], off offset:-1024
L_sj15:
    v_pk_mul_f32 v[30:31], v[22:23], v[28:29] op_sel_hi:[1,0]
    v_pk_mul_f32 v[6:7], v[4:5], v[28:29] op_sel_hi:[1,0]
    v_pk_fma_f32 v[22:23], v[22:23], v[28:29], v[30:31] op_sel:[1,1,0] op_sel_hi:[0,1,1] neg_lo:[1,0,0]
    v_pk_fma_f32 v[4:5], v[4:5], v[28:29], v[6:7] op_sel:[1,1,0] op_sel_hi:[0,1,1] neg_lo:[1,0,0]
    v_cvt_pk_bf16_f32 v32, v22, -v23
    v_cvt_pk_bf16_f32 v33, v4, -v5
    ds_write_addtid_b32 v32 offset:10320
    ds_write_addtid_b32 v33 offset:12384
    v_pk_mul_f32 v[30:31], v[22:23], v[28:29] op_sel_hi:[1,0]
    v_pk_mul_f32 v[6:7], v[4:5], v[28:29] op_sel_hi:[1,0]
    v_pk_fma_f32 v[22:23], v[22:23], v[28:29], v[30:31] op_sel:[1,1,0] op_sel_hi:[0,1,1] neg_lo:[1,0,0]
    v_pk_fma_f32 v[4:5], v[4:5], v[28:29], v[6:7] op_sel:[1,1,0] op_sel_hi:[0,1,1] neg_lo:[1,0,0]
    v_cvt_pk_bf16_f32 v34, v22, -v23
    v_cvt_pk_bf16_f32 v35, v4, -v5
    ds_write_addtid_b32 v34 offset:14448
    ds_write_addtid_b32 v35 offset:16512
    v_pk_mul_f32 v[30:31], v[22:23], v[28:29] op_sel_hi:[1,0]
    v_pk_mul_f32 v[6:7], v[4:5], v[28:29] op_sel_hi:[1,0]
    v_pk_fma_f32 v[22:23], v[22:23], v[28:29], v[30:31] op_sel:[1,1,0] op_sel_hi:[0,1,1] neg_lo:[1,0,0]
    v_pk_fma_f32 v[4:5], v[4:5], v[28:29], v[6:7] op_sel:[1,1,0] op_sel_hi:[0,1,1] neg_lo:[1,0,0]
    v_cvt_pk_bf16_f32 v32, v22, -v23
    v_cvt_pk_bf16_f32 v33, v4, -v5
    ds_write_addtid_b32 v32 offset:18576
    ds_write_addtid_b32 v33 offset:20640
    v_pk_mul_f32 v[30:31], v[22:23], v[28:29] op_sel_hi:[1,0]
    v_pk_mul_f32 v[6:7], v[4:5], v[28:29] op_sel_hi:[1,0]
    v_pk_fma_f32 v[22:23], v[22:23], v[28:29], v[30:31] op_sel:[1,1,0] op_sel_hi:[0,1,1] neg_lo:[1,0,0]
    v_pk_fma_f32 v[4:5], v[4:5], v[28:29], v[6:7] op_sel:[1,1,0] op_sel_hi:[0,1,1] neg_lo:[1,0,0]
    v_cvt_pk_bf16_f32 v34, v22, -v23
    v_cvt_pk_bf16_f32 v35, v4, -v5
    ds_write_addtid_b32 v34 offset:22704
    ds_write_addtid_b32 v35 offset:24768
    s_cmp_lg_u32 s51, 0
    s_cbranch_scc0 L_sj47
    s_waitcnt vmcnt(0)
    s_nop 0
    buffer_load_dword v58, v45, s[28:31], 0 offen
    buffer_load_dword v59, v45, s[28:31], 0 offen offset:1024
L_sj47:
    v_pk_mul_f32 v[30:31], v[22:23], v[28:29] op_sel_hi:[1,0]
    v_pk_mul_f32 v[6:7], v[4:5], v[28:29] op_sel_hi:[1,0]
    v_pk_fma_f32 v[22:23], v[22:23], v[28:29], v[30:31] op_sel:[1,1,0] op_sel_hi:[0,1,1] neg_lo:[1,0,0]
    v_pk_fma_f32 v[4:5], v[4:5], v[28:29], v[6:7] op_sel:[1,1,0] op_sel_hi:[0,1,1] neg_lo:[1,0,0]
    v_cvt_pk_bf16_f32 v32, v22, -v23
    v_cvt_pk_bf16_f32 v33, v4, -v5
    ds_write_addtid_b32 v32 offset:26832
    ds_write_addtid_b32 v33 offset:28896
    v_pk_mul_f32 v[30:31], v[22:23], v[28:29] op_sel_hi:[1,0]
    v_pk_mul_f32 v[6:7], v[4:5], v[28:29] op_sel_hi:[1,0]
    v_pk_fma_f32 v[22:23], v[22:23], v[28:29], v[30:31] op_sel:[1,1,0] op_sel_hi:[0,1,1] neg_lo:[1,0,0]
    v_pk_fma_f32 v[4:5], v[4:5], v[28:29], v[6:7] op_sel:[1,1,0] op_sel_hi:[0,1,1] neg_lo:[1,0,0]
    v_cvt_pk_bf16_f32 v34, v22, -v23
    v_cvt_pk_bf16_f32 v35, v4, -v5
    ds_write_addtid_b32 v34 offset:30960
    ds_write_addtid_b32 v35 offset:33024
    v_pk_mul_f32 v[30:31], v[22:23], v[28:29] op_sel_hi:[1,0]
    v_pk_mul_f32 v[6:7], v[4:5], v[28:29] op_sel_hi:[1,0]
    v_pk_fma_f32 v[22:23], v[22:23], v[28:29], v[30:31] op_sel:[1,1,0] op_sel_hi:[0,1,1] neg_lo:[1,0,0]
    v_pk_fma_f32 v[4:5], v[4:5], v[28:29], v[6:7] op_sel:[1,1,0] op_sel_hi:[0,1,1] neg_lo:[1,0,0]
    v_cvt_pk_bf16_f32 v32, v22, -v23
    v_cvt_pk_bf16_f32 v33, v4, -v5
    ds_write_addtid_b32 v32 offset:35088
    ds_write_addtid_b32 v33 offset:37152
    v_pk_mul_f32 v[30:31], v[22:23], v[28:29] op_sel_hi:[1,0]
    v_pk_mul_f32 v[6:7], v[4:5], v[28:29] op_sel_hi:[1,0]
    v_pk_fma_f32 v[22:23], v[22:23], v[28:29], v[30:31] op_sel:[1,1,0] op_sel_hi:[0,1,1] neg_lo:[1,0,0]
    v_pk_fma_f32 v[4:5], v[4:5], v[28:29], v[6:7] op_sel:[1,1,0] op_sel_hi:[0,1,1] neg_lo:[1,0,0]
    v_cvt_pk_bf16_f32 v34, v22, -v23
    v_cvt_pk_bf16_f32 v35, v4, -v5
    ds_write_addtid_b32 v34 offset:39216
    ds_write_addtid_b32 v35 offset:41280
    v_pk_mul_f32 v[30:31], v[22:23], v[28:29] op_sel_hi:[1,0]
    v_pk_mul_f32 v[6:7], v[4:5], v[28:29] op_sel_hi:[1,0]
    v_pk_fma_f32 v[22:23], v[22:23], v[28:29], v[30:31] op_sel:[1,1,0] op_sel_hi:[0,1,1] neg_lo:[1,0,0]
    v_pk_fma_f32 v[4:5], v[4:5], v[28:29], v[6:7] op_sel:[1,1,0] op_sel_hi:[0,1,1] neg_lo:[1,0,0]
    v_cvt_pk_bf16_f32 v32, v22, -v23
    v_cvt_pk_bf16_f32 v33, v4, -v5
    ds_write_addtid_b32 v32 offset:43344
    ds_write_addtid_b32 v33 offset:45408
    v_pk_mul_f32 v[30:31], v[22:23], v[28:29] op_sel_hi:[1,0]
    v_pk_mul_f32 v[6:7], v[4:5], v[28:29] op_sel_hi:[1,0]
    v_pk_fma_f32 v[22:23], v[22:23], v[28:29], v[30:31] op_sel:[1,1,0] op_sel_hi:[0,1,1] neg_lo:[1,0,0]
    v_pk_fma_f32 v[4:5], v[4:5], v[28:29], v[6:7] op_sel:[1,1,0] op_sel_hi:[0,1,1] neg_lo:[1,0,0]
    v_cvt_pk_bf16_f32 v34, v22, -v23
    v_cvt_pk_bf16_f32 v35, v4, -v5
    ds_write_addtid_b32 v34 offset:47472
    ds_write_addtid_b32 v35 offset:49536
    v_pk_mul_f32 v[30:31], v[22:23], v[28:29] op_sel_hi:[1,0]
    v_pk_mul_f32 v[6:7], v[4:5], v[28:29] op_sel_hi:[1,0]
    v_pk_fma_f32 v[22:23], v[22:23], v[28:29], v[30:31] op_sel:[1,1,0] op_sel_hi:[0,1,1] neg_lo:[1,0,0]
    v_pk_fma_f32 v[4:5], v[4:5], v[28:29], v[6:7] op_sel:[1,1,0] op_sel_hi:[0,1,1] neg_lo:[1,0,0]
    v_cvt_pk_bf16_f32 v32, v22, -v23
    v_cvt_pk_bf16_f32 v33, v4, -v5
    ds_write_addtid_b32 v32 offset:51600
    ds_write_addtid_b32 v33 offset:53664
    v_pk_mul_f32 v[30:31], v[22:23], v[28:29] op_sel_hi:[1,0]
    v_pk_mul_f32 v[6:7], v[4:5], v[28:29] op_sel_hi:[1,0]
    v_pk_fma_f32 v[22:23], v[22:23], v[28:29], v[30:31] op_sel:[1,1,0] op_sel_hi:[0,1,1] neg_lo:[1,0,0]
    v_pk_fma_f32 v[4:5], v[4:5], v[28:29], v[6:7] op_sel:[1,1,0] op_sel_hi:[0,1,1] neg_lo:[1,0,0]
    v_cvt_pk_bf16_f32 v34, v22, -v23
    v_cvt_pk_bf16_f32 v35, v4, -v5
    ds_write_addtid_b32 v34 offset:55728
    ds_write_addtid_b32 v35 offset:57792
    v_pk_mul_f32 v[30:31], v[22:23], v[28:29] op_sel_hi:[1,0]
    v_pk_mul_f32 v[6:7], v[4:5], v[28:29] op_sel_hi:[1,0]
    v_pk_fma_f32 v[22:23], v[22:23], v[28:29], v[30:31] op_sel:[1,1,0] op_sel_hi:[0,1,1] neg_lo:[1,0,0]
    v_pk_fma_f32 v[4:5], v[4:5], v[28:29], v[6:7] op_sel:[1,1,0] op_sel_hi:[0,1,1] neg_lo:[1,0,0]
    v_cvt_pk_bf16_f32 v32, v22, -v23
    v_cvt_pk_bf16_f32 v33, v4, -v5
    ds_write_addtid_b32 v32 offset:59856
    ds_write_addtid_b32 v33 offset:61920
    s_cmp_lg_u32 s51, 0
    s_cbranch_scc1 L_sj119
    s_waitcnt vmcnt(12)
    s_nop 0
    v_mul_lo_u32 v9, v9, s42
    v_add_u32 v9, 0x7F4A7C15, v9
    v_dot2_f32_bf16 v2, v76, v84, 0
    v_dot2_f32_bf16 v3, v80, v88, 0
    v_dot2_f32_bf16 v2, v77, v85, v2
    v_dot2_f32_bf16 v3, v81, v89, v3
    v_dot2_f32_bf16 v2, v78, v86, v2
    v_dot2_f32_bf16 v3, v82, v90, v3
    v_dot2_f32_bf16 v2, v79, v87, v2
    v_dot2_f32_bf16 v3, v83, v91, v3
    s_nop 2
    v_add_f32_e64 v2, v2, v3
    s_nop 1
    v_add_f32_dpp v2, v2, v2 row_ror:8 row_mask:0xf bank_mask:0xf
    s_nop 1
    v_add_f32_dpp v2, v2, v2 row_ror:4 row_mask:0xf bank_mask:0xf
    s_nop 1
    v_add_f32_dpp v2, v2, v2 row_ror:2 row_mask:0xf bank_mask:0xf
    s_nop 1
    v_add_f32_dpp v2, v2, v2 row_ror:1 row_mask:0xf bank_mask:0xf
    s_nop 1
    v_add_f32_dpp v2, v2, v2 row_bcast:15 row_mask:0xa bank_mask:0xf
    v_mul_f32 v2, 0xbfb8aa3b, v2
    v_exp_f32 v2, v2
    s_nop 0
    v_add_f32 v2, 1.0, v2
    v_rcp_f32_e64 v2, v2
    s_nop 1
    v_mov_b32_dpp v3, v2 row_bcast:31 row_mask:0xc bank_mask:0xf
    v_cvt_pk_bf16_f32 v8, v3, v2
    s_lshl_b64 exec, 1, 63
    buffer_store_dwordx2 v[8:9], v59, s[36:39], 0 offen sc1
    ds_write_b32 v106, v9
    s_mov_b64 exec, -1
L_sj119:
    v_pk_mul_f32 v[30:31], v[22:23], v[28:29] op_sel_hi:[1,0]
    v_pk_mul_f32 v[6:7], v[4:5], v[28:29] op_sel_hi:[1,0]
    v_pk_fma_f32 v[22:23], v[22:23], v[28:29], v[30:31] op_sel:[1,1,0] op_sel_hi:[0,1,1] neg_lo:[1,0,0]
    v_pk_fma_f32 v[4:5], v[4:5], v[28:29], v[6:7] op_sel:[1,1,0] op_sel_hi:[0,1,1] neg_lo:[1,0,0]
    v_cvt_pk_bf16_f32 v34, v22, -v23
    ds_write_addtid_b32 v34 offset:63984
    s_add_u32 s56, s63, 63000
    s_mov_b32 m0, s56
    s_nop 0
    v_pk_mul_f32 v[6:7], v[24:25], v[4:5] op_sel_hi:[1,0]
    v_pk_fma_f32 v[26:27], v[24:25], v[4:5], v[6:7] op_sel:[1,1,0] op_sel_hi:[0,1,1] neg_lo:[1,0,0]
    v_cvt_pk_bf16_f32 v35, v24, v25
    v_cvt_pk_bf16_f32 v32, v26, v27
    ds_write_addtid_b32 v35 offset:34008
    ds_write_addtid_b32 v32 offset:13368
    s_cmp_lg_u32 s51, 0
    s_cbranch_scc1 L_sj133
    s_lshl_b32 s59, s40, 9
    s_waitcnt vmcnt(8)
    v_add_u32 v42, s59, v42
    v_add_u32 v43, s59, v43
    ds_read_b128 a[64:67], v43 offset:0
    ds_read_b128 a[68:71], v43 offset:32
    ds_read_b128 a[72:75], v43 offset:64
    ds_read_b128 a[76:79], v43 offset:96
L_sj133:
    v_pk_mul_f32 v[30:31], v[24:25], v[18:19] op_sel_hi:[1,0]
    v_pk_mul_f32 v[6:7], v[26:27], v[20:21] op_sel_hi:[1,0]
    v_pk_fma_f32 v[24:25], v[24:25], v[18:19], v[30:31] op_sel:[1,1,0] op_sel_hi:[0,1,1] neg_lo:[1,0,0]
    v_pk_fma_f32 v[22:23], v[26:27], v[20:21], v[6:7] op_sel:[1,1,0] op_sel_hi:[0,1,1] neg_lo:[1,0,0]
    v_cvt_pk_bf16_f32 v33, v24, v25
    v_cvt_pk_bf16_f32 v34, v22, v23
    ds_write_addtid_b32 v33 offset:31944
    ds_write_addtid_b32 v34 offset:36072
    v_pk_mul_f32 v[30:31], v[24:25], v[18:19] op_sel_hi:[1,0]
    v_pk_mul_f32 v[6:7], v[26:27], v[4:5] op_sel_hi:[1,0]
    v_pk_fma_f32 v[24:25], v[24:25], v[18:19], v[30:31] op_sel:[1,1,0] op_sel_hi:[0,1,1] neg_lo:[1,0,0]
    v_pk_fma_f32 v[26:27], v[26:27], v[4:5], v[6:7] op_sel:[1,1,0] op_sel_hi:[0,1,1] neg_lo:[1,0,0]
    v_cvt_pk_bf16_f32 v35, v24, v25
    v_cvt_pk_bf16_f32 v32, v26, v27
    ds_write_addtid_b32 v35 offset:29880
    ds_write_addtid_b32 v32 offset:40200
    v_pk_mul_f32 v[30:31], v[24:25], v[4:5] op_sel_hi:[1,0]
    v_pk_mul_f32 v[6:7], v[26:27], v[4:5] op_sel_hi:[1,0]
    v_pk_fma_f32 v[22:23], v[24:25], v[4:5], v[30:31] op_sel:[1,1,0] op_sel_hi:[0,1,1] neg_lo:[1,0,0]
    v_pk_fma_f32 v[26:27], v[26:27], v[4:5], v[6:7] op_sel:[1,1,0] op_sel_hi:[0,1,1] neg_lo:[1,0,0]
    v_cvt_pk_bf16_f32 v33, v22, v23
    v_cvt_pk_bf16_f32 v34, v26, v27
    ds_write_addtid_b32 v33 offset:11304
    ds_write_addtid_b32 v34 offset:19560
    v_pk_mul_f32 v[30:31], v[24:25], v[18:19] op_sel_hi:[1,0]
    v_pk_mul_f32 v[6:7], v[26:27], v[4:5] op_sel_hi:[1,0]
    v_pk_fma_f32 v[24:25], v[24:25], v[18:19], v[30:31] op_sel:[1,1,0] op_sel_hi:[0,1,1] neg_lo:[1,0,0]
    v_pk_fma_f32 v[26:27], v[26:27], v[4:5], v[6:7] op_sel:[1,1,0] op_sel_hi:[0,1,1] neg_lo:[1,0,0]
    v_cvt_pk_bf16_f32 v35, v24, v25
    v_cvt_pk_bf16_f32 v32, v26, v27
    ds_write_addtid_b32 v35 offset:27816
    ds_write_addtid_b32 v32 offset:44328
    s_cmp_lg_u32 s51, 0
    s_cbranch_scc1 L_sj165
    ds_read_b128 a[80:83], v43 offset:128
    ds_read_b128 a[84:87], v43 offset:160
    ds_read_b128 a[88:91], v43 offset:192
    ds_read_b128 a[92:95], v43 offset:224
L_sj165:
    v_pk_mul_f32 v[30:31], v[24:25], v[18:19] op_sel_hi:[1,0]
    v_pk_mul_f32 v[6:7], v[26:27], v[4:5] op_sel_hi:[1,0]
    v_pk_fma_f32 v[24:25], v[24:25], v[18:19], v[30:31] op_sel:[1,1,0] op_sel_hi:[0,1,1] neg_lo:[1,0,0]
    v_pk_fma_f32 v[26:27], v[26:27], v[4:5], v[6:7] op_sel:[1,1,0] op_sel_hi:[0,1,1] neg_lo:[1,0,0]
    v_cvt_pk_bf16_f32 v33, v24, v25
    v_cvt_pk_bf16_f32 v34, v26, v27
    ds_write_addtid_b32 v33 offset:9240
    ds_write_addtid_b32 v34 offset:46392
    v_pk_mul_f32 v[30:31], v[24:25], v[4:5] op_sel_hi:[1,0]
    v_pk_mul_f32 v[6:7], v[26:27], v[4:5] op_sel_hi:[1,0]
    v_pk_fma_f32 v[22:23], v[24:25], v[4:5], v[30:31] op_sel:[1,1,0] op_sel_hi:[0,1,1] neg_lo:[1,0,0]
    v_pk_fma_f32 v[26:27], v[26:27], v[4:5], v[6:7] op_sel:[1,1,0] op_sel_hi:[0,1,1] neg_lo:[1,0,0]
    v_cvt_pk_bf16_f32 v35, v22, v23
    v_cvt_pk_bf16_f32 v32, v26, v27
    ds_write_addtid_b32 v35 offset:15432
    ds_write_addtid_b32 v32 offset:23688
    s_cmp_lg_u32 s51, 0
    s_cbranch_scc1 L_sj181
    ds_bpermute_b32 v96, v104, v92
    ds_bpermute_b32 v98, v104, v93
    ds_bpermute_b32 v100, v104, v94
    ds_bpermute_b32 v102, v104, v95
    v_mov_b32 v97, v9
    v_mov_b32 v99, v9
    v_mov_b32 v101, v9
    v_mov_b32 v103, v9
L_sj181:
    v_pk_mul_f32 v[30:31], v[24:25], v[18:19] op_sel_hi:[1,0]
    v_pk_mul_f32 v[6:7], v[26:27], v[4:5] op_sel_hi:[1,0]
    v_pk_fma_f32 v[24:25], v[24:25], v[18:19], v[30:31] op_sel:[1,1,0] op_sel_hi:[0,1,1] neg_lo:[1,0,0]
    v_pk_fma_f32 v[26:27], v[26:27], v[4:5], v[6:7] op_sel:[1,1,0] op_sel_hi:[0,1,1] neg_lo:[1,0,0]
    v_cvt_pk_bf16_f32 v33, v24, v25
    v_cvt_pk_bf16_f32 v34, v26, v27
    ds_write_addtid_b32 v33 offset:7176
    ds_write_addtid_b32 v34 offset:25752
    v_pk_mul_f32 v[30:31], v[24:25], v[18:19] op_sel_hi:[1,0]
    v_pk_mul_f32 v[6:7], v[22:23], v[4:5] op_sel_hi:[1,0]
    v_pk_fma_f32 v[24:25], v[24:25], v[18:19], v[30:31] op_sel:[1,1,0] op_sel_hi:[0,1,1] neg_lo:[1,0,0]
    v_pk_fma_f32 v[22:23], v[22:23], v[4:5], v[6:7] op_sel:[1,1,0] op_sel_hi:[0,1,1] neg_lo:[1,0,0]
    v_cvt_pk_bf16_f32 v35, v24, v25
    v_cvt_pk_bf16_f32 v32, v22, v23
    ds_write_addtid_b32 v35 offset:5112
    ds_write_addtid_b32 v32 offset:42264
    s_cmp_lg_u32 s51, 0
    s_cbranch_scc1 L_sj197
    s_waitcnt lgkmcnt(0)
    s_nop 0
    buffer_store_dwordx4 v[96:99], v105, s[36:39], 0 offen sc1
    buffer_store_dwordx4 v[100:103], v105, s[36:39], 0 offen offset:128 sc1
L_sj197:
    v_pk_mul_f32 v[30:31], v[26:27], v[20:21] op_sel_hi:[1,0]
    v_pk_mul_f32 v[6:7], v[22:23], v[4:5] op_sel_hi:[1,0]
    v_pk_fma_f32 v[26:27], v[26:27], v[20:21], v[30:31] op_sel:[1,1,0] op_sel_hi:[0,1,1] neg_lo:[1,0,0]
    v_pk_fma_f32 v[22:23], v[22:23], v[4:5], v[6:7] op_sel:[1,1,0] op_sel_hi:[0,1,1] neg_lo:[1,0,0]
    v_cvt_pk_bf16_f32 v33, v26, v27
    v_cvt_pk_bf16_f32 v34, v22, v23
    ds_write_addtid_b32 v33 offset:17496
    ds_write_addtid_b32 v34 offset:21624
    s_cmp_lg_u32 s51, 0
    s_cbranch_scc0 L_sj205
    buffer_load_dword v60, v45, s[28:31], s42 offen
L_sj205:
    v_pk_mul_f32 v[30:31], v[24:25], v[4:5] op_sel_hi:[1,0]
    v_pk_mul_f32 v[6:7], v[24:25], v[18:19] op_sel_hi:[1,0]
    v_pk_fma_f32 v[22:23], v[24:25], v[4:5], v[30:31] op_sel:[1,1,0] op_sel_hi:[0,1,1] neg_lo:[1,0,0]
    v_pk_fma_f32 v[24:25], v[24:25], v[18:19], v[6:7] op_sel:[1,1,0] op_sel_hi:[0,1,1] neg_lo:[1,0,0]
    v_cvt_pk_bf16_f32 v35, v22, v23
    v_cvt_pk_bf16_f32 v32, v24, v25
    ds_write_addtid_b32 v35 offset:38136
    ds_write_addtid_b32 v32 offset:3048
    s_cmp_lg_u32 s51, 0
    s_cbranch_scc1 L_so213
    s_mul_i32 s7, s41, 8320
    s_lshl_b32 s57, s47, 7
    s_add_u32 s56, s7, s57
    s_waitcnt vmcnt(8)
    v_add_u32 v50, s7, v50
    v_add_u32 v51, s7, v51
    s_waitcnt vmcnt(7)
    v_add_u32 v55, s56, v55
    s_lshl_b32 s56, s47, 8
    v_add_u32 v40, s56, v50
    s_lshl_b32 s56, s47, 9
    v_subrev_u32_e64 v39, s56, v51
    s_mul_i32 s7, s41, 5120
    s_sub_u32 s56, s7, s57
    v_add_u32 v52, s56, v52
    v_add_u32 v53, s7, v53
    v_add_u32 v54, s7, v54
    s_lshl_b32 s46, s41, 1
    s_add_u32 s46, s46, s47
    s_lshl_b32 s56, s46, 10
    v_add_u32 v49, s56, v49
    s_mul_i32 s59, s46, 2560
    v_add_u32 v44, s59, v44
    v_add_u32 v48, s59, v48
    s_add_u32 s56, s59, s57
    v_add_u32 v45, s56, v45
    s_lshr_b32 s57, s57, 1
    s_add_u32 s56, s59, s57
    v_add_u32 v46, s56, v46
    v_add_u32 v47, s56, v47
    s_lshl_b32 s56, s41, 4
    s_lshr_b32 s49, s49, s56
    s_lshl_b32 s49, s49, 16
    v_mov_b32 v41, 0
    v_writelane_b32 v41, s49, 32
    s_mov_b64 s[52:53], 1
    v_add_u32 v56, 0x400, v55
    v_add_u32 v57, 0x800, v55
    v_add_u32 v58, 0xc00, v55
    s_branch L_sj213
L_so213:
    buffer_load_dword v61, v45, s[28:31], s42 offen offset:1024
    s_waitcnt vmcnt(2)
    s_nop 0
    v_perm_b32 v2, v59, v58, s8
    v_perm_b32 v3, v59, v58, s9
    ds_write_b16 v43, v58 offset:4222
    ds_write_b16_d16_hi v43, v58 offset:12542
    ds_write_b32 v43, v2 offset:64
    ds_write_b32 v43, v3 offset:8384
    ds_write_b16 v43, v59 offset:4224
    ds_write_b16_d16_hi v43, v59 offset:12544
L_sj213:
    s_waitcnt lgkmcnt(0)
    s_barrier
    s_cmp_lg_u32 s51, 0
    s_cbranch_scc1 L_opost
    ds_read_b128 v[76:79], v42 offset:0
    ds_read_b128 v[84:87], v42 offset:32
    ds_read_b128 v[92:95], v42 offset:64
    ds_read_b128 v[100:103], v42 offset:96
    s_waitcnt lgkmcnt(3)
    v_mfma_f32_32x32x16_bf16 v[108:123], v[76:79], a[64:67], 0
    ds_read_b128 v[12:15], v40
    ds_read_b128 v[76:79], v42 offset:128
    s_waitcnt lgkmcnt(4)
    v_mfma_f32_32x32x16_bf16 v[108:123], v[84:87], a[68:71], v[108:123]
    ds_read_b128 v[16:19], v40 offset:512
    ds_read_b128 v[84:87], v42 offset:160
    s_waitcnt lgkmcnt(5)
    v_mfma_f32_32x32x16_bf16 v[108:123], v[92:95], a[72:75], v[108:123]
    ds_read_b128 v[20:23], v39 offset:512
    ds_read_b128 v[92:95], v42 offset:192
    s_waitcnt lgkmcnt(6)
    v_mfma_f32_32x32x16_bf16 v[108:123], v[100:103], a[76:79], v[108:123]
    ds_read_b128 v[24:27], v39 offset:528
    ds_read_b128 v[100:103], v42 offset:224
    s_waitcnt lgkmcnt(6)
    v_mfma_f32_32x32x16_bf16 v[108:123], v[76:79], a[80:83], v[108:123]
    ds_read2_b32 a[0:1], v55 offset0:0 offset1:1
    ds_read_b128 v[76:79], v42 offset:256
    ds_read_b128 v[80:83], v43 offset:256
    s_waitcnt lgkmcnt(7)
    v_mfma_f32_32x32x16_bf16 v[108:123], v[84:87], a[84:87], v[108:123]
    ds_read_b128 v[84:87], v42 offset:288
    ds_read_b128 v[88:91], v43 offset:288
    s_waitcnt lgkmcnt(7)
    v_mfma_f32_32x32x16_bf16 v[108:123], v[92:95], a[88:91], v[108:123]
    ds_read_b128 v[92:95], v42 offset:320
    ds_read_b128 v[96:99], v43 offset:320
    s_waitcnt lgkmcnt(7)
    v_mfma_f32_32x32x16_bf16 v[108:123], v[100:103], a[92:95], v[108:123]
    ds_read_b128 v[100:103], v42 offset:352
    ds_read_b128 v[104:107], v43 offset:352
    s_waitcnt lgkmcnt(6)
    v_mfma_f32_32x32x16_bf16 v[108:123], v[76:79], v[80:83], v[108:123]
    ds_read_b128 v[76:79], v42 offset:384
    ds_read_b128 v[80:83], v43 offset:384
    s_waitcnt lgkmcnt(6)
    v_mfma_f32_32x32x16_bf16 v[108:123], v[84:87], v[88:91], v[108:123]
    ds_read_b128 v[84:87], v42 offset:416
    ds_read_b128 v[88:91], v43 offset:416
    s_waitcnt lgkmcnt(6)
    v_mfma_f32_32x32x16_bf16 v[108:123], v[92:95], v[96:99], v[108:123]
    ds_read_b128 v[92:95], v42 offset:448
    ds_read_b128 v[96:99], v43 offset:448
    s_waitcnt lgkmcnt(6)
    v_mfma_f32_32x32x16_bf16 v[108:123], v[100:103], v[104:107], v[108:123]
    ds_read_b128 v[100:103], v42 offset:480
    ds_read_b128 v[104:107], v43 offset:480
    s_waitcnt lgkmcnt(6)
    v_mfma_f32_32x32x16_bf16 v[108:123], v[76:79], v[80:83], v[108:123]
    s_waitcnt lgkmcnt(4)
    v_mfma_f32_32x32x16_bf16 v[108:123], v[84:87], v[88:91], v[108:123]
    ds_read2_b32 a[2:3], v55 offset0:2 offset1:3
    ds_read2_b32 a[4:5], v55 offset0:16 offset1:17
    s_waitcnt lgkmcnt(4)
    v_mfma_f32_32x32x16_bf16 v[108:123], v[92:95], v[96:99], v[108:123]
    ds_read2_b32 a[6:7], v55 offset0:18 offset1:19
    ds_read2_b32 a[8:9], v55 offset0:64 offset1:65
    s_waitcnt lgkmcnt(4)
    v_mfma_f32_32x32x16_bf16 v[108:123], v[100:103], v[104:107], v[108:123]
    ds_read2_b32 a[10:11], v55 offset0:66 offset1:67
    ds_read2_b32 a[12:13], v55 offset0:80 offset1:81
    ds_read2_b32 a[14:15], v55 offset0:82 offset1:83
    ds_read2_b32 a[16:17], v55 offset0:128 offset1:129
    ds_read2_b32 a[18:19], v55 offset0:130 offset1:131
    s_waitcnt vmcnt(6)
    v_mfma_f32_16x16x32_bf16 v[76:79], v[12:15], v[60:63], 0
    ds_read2_b32 a[20:21], v55 offset0:144 offset1:145
    ds_read2_b32 a[22:23], v55 offset0:146 offset1:147
    ds_read2_b32 a[24:25], v55 offset0:192 offset1:193
    s_waitcnt vmcnt(5)
    v_mfma_f32_16x16x32_bf16 v[80:83], v[12:15], v[64:67], 0
    ds_read2_b32 a[26:27], v55 offset0:194 offset1:195
    ds_read2_b32 a[28:29], v55 offset0:208 offset1:209
    ds_read2_b32 a[30:31], v55 offset0:210 offset1:211
    v_add_f32_e64 v111, v111, v41
    v_cvt_pk_bf16_f32 v2, v108, v109
    v_cvt_pk_bf16_f32 v3, v110, v111
    v_cvt_pk_bf16_f32 v4, v112, v113
    v_cvt_pk_bf16_f32 v5, v114, v115
    ds_write_b64 v44, v[2:3]
    ds_write_b64 v44, v[4:5] offset:512
    v_mfma_f32_16x16x32_bf16 v[84:87], v[16:19], v[60:63], 0
    v_mov_b32_dpp v2, v116 row_shl:1 row_mask:0xf bank_mask:0xf bound_ctrl:0
    v_mfma_f32_16x16x32_bf16 v[88:91], v[16:19], v[64:67], 0
    v_cndmask_b32 v3, v116, v118, s[52:53]
    s_waitcnt vmcnt(4)
    v_mfma_f32_16x16x32_bf16 v[92:95], v[20:23], v[68:71], 0
    v_cndmask_b32 v8, v117, v118, s[52:53]
    s_waitcnt vmcnt(3)
    v_mfma_f32_16x16x32_bf16 v[96:99], v[24:27], v[72:75], 0
    v_writelane_b32 v2, 0, 1
    s_bitcmp1_b32 s47, 0
    s_waitcnt lgkmcnt(0)
    s_barrier
    s_cbranch_scc1 L_m1
    ds_read_b128 a[64:67], v52 offset:64
    ds_read_b128 a[84:87], v52 offset:0
    ds_read_b128 a[68:71], v52 offset:320
    ds_read_b128 a[88:91], v52 offset:256
    ds_read_b128 a[72:75], v52 offset:576
    ds_read_b128 a[92:95], v52 offset:512
    ds_read_b128 a[76:79], v52 offset:832
    ds_read_b128 a[96:99], v52 offset:768
    v_cvt_pk_bf16_f32 v28, v76, v80
    v_cvt_pk_bf16_f32 v29, v77, v81
    v_cvt_pk_bf16_f32 v30, v78, v82
    v_cvt_pk_bf16_f32 v31, v79, v83
    v_cvt_pk_bf16_f32 v32, v84, v88
    v_cvt_pk_bf16_f32 v33, v85, v89
    v_cvt_pk_bf16_f32 v34, v86, v90
    v_cvt_pk_bf16_f32 v35, v87, v91
    v_cvt_pk_bf16_f32 v100, v92, v96
    v_cvt_pk_bf16_f32 v101, v93, v97
    v_cvt_pk_bf16_f32 v102, v94, v98
    v_cvt_pk_bf16_f32 v103, v95, v99
    s_waitcnt lgkmcnt(7)
    v_mfma_f32_16x16x32_bf16 a[104:107], a[0:3], a[64:67], 0
    v_cvt_pk_bf16_f32 v8, v3, v8
    ds_write_b32 v45, v8
    s_waitcnt lgkmcnt(7)
    v_mfma_f32_16x16x32_bf16 a[104:107], a[4:7], a[84:87], a[104:107]
    v_cvt_pk_bf16_f32 v4, v2, v2
    v_cvt_pk_bf16_f32 v5, v117, v117
    s_waitcnt lgkmcnt(6)
    v_mfma_f32_16x16x32_bf16 a[108:111], a[0:3], a[68:71], 0
    v_cvt_pk_bf16_f32 v6, v117, v116
    v_cvt_pk_bf16_f32 v7, v116, v116
    ds_write_b128 v48, v[4:7]
    s_waitcnt lgkmcnt(6)
    v_mfma_f32_16x16x32_bf16 a[108:111], a[4:7], a[88:91], a[108:111]
    v_writelane_b32 v118, 0, 0
    v_cvt_pk_bf16_f32 v3, v120, v120
    v_mfma_f32_16x16x32_bf16 a[108:111], a[8:11], a[64:67], a[108:111]
    v_cvt_pk_bf16_f32 v2, v118, v119
    ds_write_b16 v47, v3
    v_mfma_f32_16x16x32_bf16 a[108:111], a[12:15], a[84:87], a[108:111]
    ds_write_b16 v46, v2 offset:64
    s_waitcnt lgkmcnt(7)
    v_mfma_f32_16x16x32_bf16 a[112:115], a[0:3], a[72:75], 0
    ds_write_b16_d16_hi v46, v2
    s_waitcnt lgkmcnt(7)
    v_mfma_f32_16x16x32_bf16 a[112:115], a[4:7], a[92:95], a[112:115]
    v_mfma_f32_16x16x32_bf16 a[112:115], a[8:11], a[68:71], a[112:115]
    v_mfma_f32_16x16x32_bf16 a[112:115], a[12:15], a[88:91], a[112:115]
    v_mfma_f32_16x16x32_bf16 a[112:115], a[16:19], a[64:67], a[112:115]
    v_mfma_f32_16x16x32_bf16 a[112:115], a[20:23], a[84:87], a[112:115]
    s_waitcnt lgkmcnt(6)
    v_mfma_f32_16x16x32_bf16 a[116:119], a[0:3], a[76:79], 0
    s_waitcnt lgkmcnt(0)
    s_barrier
    ds_read_b128 a[80:83], v52 offset:1088
    ds_read_b128 a[100:103], v52 offset:1024
    v_mfma_f32_16x16x32_bf16 a[116:119], a[4:7], a[96:99], a[116:119]
    ds_read_b64 v[14:15], v53 offset:8
    v_mfma_f32_16x16x32_bf16 a[116:119], a[8:11], a[72:75], a[116:119]
    ds_write_b128 v49, a[104:107] offset:0
    v_mfma_f32_16x16x32_bf16 a[116:119], a[12:15], a[92:95], a[116:119]
    ds_read_b64 v[12:13], v53 offset:0
    v_mfma_f32_16x16x32_bf16 a[116:119], a[16:19], a[68:71], a[116:119]
    ds_read2_b32 a[34:35], v56 offset0:2 offset1:3
    v_mfma_f32_16x16x32_bf16 a[116:119], a[20:23], a[88:91], a[116:119]
    ds_write_b128 v49, a[108:111] offset:4096
    v_mfma_f32_16x16x32_bf16 a[116:119], a[24:27], a[64:67], a[116:119]
    ds_read2_b32 a[32:33], v56 offset0:0 offset1:1
    v_mfma_f32_16x16x32_bf16 a[116:119], a[28:31], a[84:87], a[116:119]
    ds_read2_b32 a[38:39], v56 offset0:18 offset1:19
    s_waitcnt lgkmcnt(8)
    v_mfma_f32_16x16x32_bf16 a[120:123], a[0:3], a[80:83], 0
    ds_write_b128 v49, a[112:115] offset:8192
    s_waitcnt lgkmcnt(8)
    v_mfma_f32_16x16x32_bf16 a[120:123], a[4:7], a[100:103], a[120:123]
    ds_read2_b32 a[36:37], v56 offset0:16 offset1:17
    v_mfma_f32_16x16x32_bf16 a[120:123], a[8:11], a[76:79], a[120:123]
    v_mfma_f32_16x16x32_bf16 a[120:123], a[12:15], a[96:99], a[120:123]
    ds_write_b128 v49, a[116:119] offset:12288
    v_mfma_f32_16x16x32_bf16 a[120:123], a[16:19], a[72:75], a[120:123]
    v_mfma_f32_16x16x32_bf16 a[120:123], a[20:23], a[92:95], a[120:123]
    s_waitcnt lgkmcnt(7)
    v_mfma_f32_16x16x32_bf16 a[120:123], v[28:31], v[12:15], a[120:123]
    v_mfma_f32_16x16x32_bf16 a[120:123], a[24:27], a[68:71], a[120:123]
    s_waitcnt lgkmcnt(0)
    s_barrier
    ds_read_b64 v[18:19], v53 offset:72
    v_mfma_f32_16x16x32_bf16 a[120:123], a[28:31], a[88:91], a[120:123]
    ds_read_b64 v[16:17], v53 offset:64
    v_mfma_f32_16x16x32_bf16 a[120:123], a[32:35], a[64:67], a[120:123]
    ds_read2_b32 a[42:43], v56 offset0:66 offset1:67
    v_mfma_f32_16x16x32_bf16 a[120:123], a[36:39], a[84:87], a[120:123]
    ds_read2_b32 a[40:41], v56 offset0:64 offset1:65
    v_mfma_f32_16x16x32_bf16 a[124:127], a[8:11], a[80:83], 0
    ds_read2_b32 a[46:47], v56 offset0:82 offset1:83
    v_mfma_f32_16x16x32_bf16 a[124:127], a[12:15], a[100:103], a[124:127]
    ds_read2_b32 a[44:45], v56 offset0:80 offset1:81
    v_mfma_f32_16x16x32_bf16 a[124:127], a[16:19], a[76:79], a[124:127]
    v_mfma_f32_16x16x32_bf16 a[124:127], a[20:23], a[96:99], a[124:127]
    s_nop 0
    ds_write_b128 v49, a[120:123] offset:16384
    v_mfma_f32_16x16x32_bf16 a[124:127], a[24:27], a[72:75], a[124:127]
    v_mfma_f32_16x16x32_bf16 a[124:127], a[28:31], a[92:95], a[124:127]
    s_waitcnt lgkmcnt(5)
    v_mfma_f32_16x16x32_bf16 a[124:127], v[28:31], v[16:19], a[124:127]
    v_mfma_f32_16x16x32_bf16 a[124:127], a[32:35], a[68:71], a[124:127]
    ds_read_b64 v[22:23], v53 offset:136
    v_mfma_f32_16x16x32_bf16 a[124:127], a[36:39], a[88:91], a[124:127]
    ds_read_b64 v[20:21], v53 offset:128
    s_waitcnt lgkmcnt(5)
    v_mfma_f32_16x16x32_bf16 a[124:127], a[40:43], a[64:67], a[124:127]
    s_waitcnt lgkmcnt(3)
    v_mfma_f32_16x16x32_bf16 a[124:127], a[44:47], a[84:87], a[124:127]
    ds_read2_b32 a[50:51], v56 offset0:130 offset1:131
    v_mfma_f32_16x16x32_bf16 a[104:107], a[16:19], a[80:83], 0
    ds_read2_b32 a[48:49], v56 offset0:128 offset1:129
    v_mfma_f32_16x16x32_bf16 a[104:107], a[20:23], a[100:103], a[104:107]
    ds_read2_b32 a[54:55], v56 offset0:146 offset1:147
    v_mfma_f32_16x16x32_bf16 a[104:107], a[24:27], a[76:79], a[104:107]
    ds_read2_b32 a[52:53], v56 offset0:144 offset1:145
    v_mfma_f32_16x16x32_bf16 a[104:107], a[28:31], a[96:99], a[104:107]
    ds_write_b128 v49, a[124:127] offset:20480
    v_mfma_f32_16x16x32_bf16 a[104:107], a[32:35], a[72:75], a[104:107]
    v_mfma_f32_16x16x32_bf16 a[104:107], a[36:39], a[92:95], a[104:107]
    ds_read_b128 v[24:27], v50 offset:1024
    s_waitcnt lgkmcnt(6)
    v_mfma_f32_16x16x32_bf16 a[104:107], v[28:31], v[20:23], a[104:107]
    v_mfma_f32_16x16x32_bf16 a[104:107], v[32:35], v[12:15], a[104:107]
    v_mfma_f32_16x16x32_bf16 a[104:107], a[40:43], a[68:71], a[104:107]
    v_mfma_f32_16x16x32_bf16 a[104:107], a[44:47], a[88:91], a[104:107]
    s_waitcnt lgkmcnt(4)
    v_mfma_f32_16x16x32_bf16 a[104:107], a[48:51], a[64:67], a[104:107]
    ds_read_b64 v[38:39], v53 offset:200
    s_waitcnt lgkmcnt(3)
    v_mfma_f32_16x16x32_bf16 a[104:107], a[52:55], a[84:87], a[104:107]
    ds_read_b64 v[36:37], v53 offset:192
    v_mfma_f32_16x16x32_bf16 a[108:111], a[24:27], a[80:83], 0
    ds_read2_b32 a[58:59], v56 offset0:194 offset1:195
    v_mfma_f32_16x16x32_bf16 a[108:111], a[28:31], a[100:103], a[108:111]
    ds_read2_b32 a[56:57], v56 offset0:192 offset1:193
    s_waitcnt lgkmcnt(4)
    v_mfma_f32_16x16x32_bf16 v[76:79], v[24:27], v[60:63], 0
    ds_read2_b32 a[62:63], v56 offset0:210 offset1:211
    v_mfma_f32_16x16x32_bf16 v[80:83], v[24:27], v[64:67], 0
    ds_write_b128 v49, a[104:107] offset:24576
    v_mfma_f32_16x16x32_bf16 a[108:111], a[32:35], a[76:79], a[108:111]
    ds_read2_b32 a[60:61], v56 offset0:208 offset1:209
    v_mfma_f32_16x16x32_bf16 a[108:111], a[36:39], a[96:99], a[108:111]
    v_mfma_f32_16x16x32_bf16 a[108:111], a[40:43], a[72:75], a[108:111]
    v_mfma_f32_16x16x32_bf16 a[108:111], a[44:47], a[92:95], a[108:111]
    s_nop 1
    v_cvt_pk_bf16_f32 v84, v76, v80
    v_cvt_pk_bf16_f32 v85, v77, v81
    s_waitcnt lgkmcnt(5)
    v_mfma_f32_16x16x32_bf16 a[108:111], v[28:31], v[36:39], a[108:111]
    v_cvt_pk_bf16_f32 v86, v78, v82
    v_cvt_pk_bf16_f32 v87, v79, v83
    v_mfma_f32_16x16x32_bf16 a[108:111], v[32:35], v[16:19], a[108:111]
    v_mfma_f32_16x16x32_bf16 a[108:111], a[48:51], a[68:71], a[108:111]
    ds_read_b64 v[90:91], v53 offset:264
    v_mfma_f32_16x16x32_bf16 a[108:111], a[52:55], a[88:91], a[108:111]
    ds_read_b64 v[88:89], v53 offset:256
    s_waitcnt lgkmcnt(5)
    v_mfma_f32_16x16x32_bf16 a[108:111], a[56:59], a[64:67], a[108:111]
    s_waitcnt lgkmcnt(2)
    v_mfma_f32_16x16x32_bf16 a[108:111], a[60:63], a[84:87], a[108:111]
    v_mfma_f32_16x16x32_bf16 a[112:115], a[32:35], a[80:83], 0
    v_mfma_f32_16x16x32_bf16 a[112:115], a[36:39], a[100:103], a[112:115]
    v_mfma_f32_16x16x32_bf16 a[112:115], a[40:43], a[76:79], a[112:115]
    v_mfma_f32_16x16x32_bf16 a[112:115], a[44:47], a[96:99], a[112:115]
    s_nop 3
    ds_write_b128 v49, a[108:111] offset:28672
    v_mfma_f32_16x16x32_bf16 a[112:115], a[48:51], a[72:75], a[112:115]
    ds_read_b128 v[92:95], v50 offset:1536
    v_mfma_f32_16x16x32_bf16 a[112:115], a[52:55], a[92:95], a[112:115]
    s_waitcnt lgkmcnt(2)
    v_mfma_f32_16x16x32_bf16 a[112:115], v[28:31], v[88:91], a[112:115]
    v_mfma_f32_16x16x32_bf16 a[112:115], v[32:35], v[20:23], a[112:115]
    s_waitcnt lgkmcnt(1)
    s_barrier
    v_mfma_f32_16x16x32_bf16 a[112:115], v[84:87], v[12:15], a[112:115]
    v_mfma_f32_16x16x32_bf16 a[112:115], a[56:59], a[68:71], a[112:115]
    v_mfma_f32_16x16x32_bf16 a[112:115], a[60:63], a[88:91], a[112:115]
    ds_read2_b32 a[2:3], v57 offset0:2 offset1:3
    v_mfma_f32_16x16x32_bf16 a[116:119], a[40:43], a[80:83], 0
    ds_read2_b32 a[0:1], v57 offset0:0 offset1:1
    v_mfma_f32_16x16x32_bf16 a[116:119], a[44:47], a[100:103], a[116:119]
    ds_read2_b32 a[6:7], v57 offset0:18 offset1:19
    s_waitcnt lgkmcnt(3)
    v_mfma_f32_16x16x32_bf16 v[96:99], v[92:95], v[60:63], 0
    ds_read2_b32 a[4:5], v57 offset0:16 offset1:17
    v_mfma_f32_16x16x32_bf16 v[104:107], v[92:95], v[64:67], 0
    ds_read2_b32 a[10:11], v57 offset0:66 offset1:67
    v_mfma_f32_16x16x32_bf16 a[116:119], a[48:51], a[76:79], a[116:119]
    ds_read2_b32 a[8:9], v57 offset0:64 offset1:65
    v_mfma_f32_16x16x32_bf16 a[116:119], a[52:55], a[96:99], a[116:119]
    ds_read2_b32 a[14:15], v57 offset0:82 offset1:83
    v_mfma_f32_16x16x32_bf16 a[116:119], a[56:59], a[72:75], a[116:119]
    ds_read2_b32 a[12:13], v57 offset0:80 offset1:81
    v_mfma_f32_16x16x32_bf16 a[116:119], a[60:63], a[92:95], a[116:119]
    v_cvt_pk_bf16_f32 v124, v96, v104
    v_cvt_pk_bf16_f32 v125, v97, v105
    v_mfma_f32_16x16x32_bf16 a[116:119], v[32:35], v[36:39], a[116:119]
    v_cvt_pk_bf16_f32 v126, v98, v106
    v_cvt_pk_bf16_f32 v127, v99, v107
    v_mfma_f32_16x16x32_bf16 a[116:119], v[84:87], v[16:19], a[116:119]
    s_waitcnt lgkmcnt(6)
    v_mfma_f32_16x16x32_bf16 a[112:115], a[0:3], a[64:67], a[112:115]
    s_waitcnt lgkmcnt(4)
    v_mfma_f32_16x16x32_bf16 a[112:115], a[4:7], a[84:87], a[112:115]
    v_mfma_f32_16x16x32_bf16 a[116:119], a[0:3], a[68:71], a[116:119]
    v_mfma_f32_16x16x32_bf16 a[116:119], a[4:7], a[88:91], a[116:119]
    ds_read2_b32 v[110:111], v54 offset0:58 offset1:59
    s_waitcnt lgkmcnt(3)
    v_mfma_f32_16x16x32_bf16 a[116:119], a[8:11], a[64:67], a[116:119]
    ds_read2_b32 v[108:109], v54 offset0:56 offset1:57
    s_waitcnt lgkmcnt(2)
    v_mfma_f32_16x16x32_bf16 a[116:119], a[12:15], a[84:87], a[116:119]
    ds_write_b128 v49, a[112:115] offset:32768
    v_mfma_f32_16x16x32_bf16 a[120:123], a[48:51], a[80:83], 0
    ds_read2_b32 a[18:19], v57 offset0:130 offset1:131
    v_mfma_f32_16x16x32_bf16 a[120:123], a[52:55], a[100:103], a[120:123]
    ds_read2_b32 a[16:17], v57 offset0:128 offset1:129
    v_mfma_f32_16x16x32_bf16 a[120:123], a[56:59], a[76:79], a[120:123]
    ds_read2_b32 a[22:23], v57 offset0:146 offset1:147
    v_mfma_f32_16x16x32_bf16 a[120:123], a[60:63], a[96:99], a[120:123]
    ds_write_b128 v49, a[116:119] offset:36864
    v_mfma_f32_16x16x32_bf16 a[120:123], a[0:3], a[72:75], a[120:123]
    ds_read2_b32 a[20:21], v57 offset0:144 offset1:145
    v_mfma_f32_16x16x32_bf16 a[120:123], a[4:7], a[92:95], a[120:123]
    v_mfma_f32_16x16x32_bf16 a[120:123], v[32:35], v[88:91], a[120:123]
    v_mfma_f32_16x16x32_bf16 a[120:123], v[84:87], v[20:23], a[120:123]
    s_waitcnt lgkmcnt(1)
    s_barrier
    ds_read_b128 v[112:115], v50 offset:2048
    v_mfma_f32_16x16x32_bf16 a[120:123], v[124:127], v[12:15], a[120:123]
    v_mfma_f32_16x16x32_bf16 a[120:123], v[100:103], v[108:111], a[120:123]
    v_mfma_f32_16x16x32_bf16 a[120:123], a[8:11], a[68:71], a[120:123]
    v_mfma_f32_16x16x32_bf16 a[120:123], a[12:15], a[88:91], a[120:123]
    v_mfma_f32_16x16x32_bf16 a[120:123], a[16:19], a[64:67], a[120:123]
    s_waitcnt lgkmcnt(1)
    v_mfma_f32_16x16x32_bf16 a[120:123], a[20:23], a[84:87], a[120:123]
    ds_read2_b32 v[118:119], v54 offset0:50 offset1:51
    v_mfma_f32_16x16x32_bf16 a[124:127], a[56:59], a[80:83], 0
    ds_read2_b32 v[116:117], v54 offset0:48 offset1:49
    v_mfma_f32_16x16x32_bf16 a[124:127], a[60:63], a[100:103], a[124:127]
    ds_read2_b32 a[26:27], v57 offset0:194 offset1:195
    s_waitcnt lgkmcnt(3)
    v_mfma_f32_16x16x32_bf16 v[120:123], v[112:115], v[60:63], 0
    ds_read2_b32 a[24:25], v57 offset0:192 offset1:193
    v_mfma_f32_16x16x32_bf16 v[24:27], v[112:115], v[64:67], 0
    ds_write_b128 v49, a[120:123] offset:40960
    v_mfma_f32_16x16x32_bf16 a[124:127], a[0:3], a[76:79], a[124:127]
    ds_read2_b32 a[30:31], v57 offset0:210 offset1:211
    v_mfma_f32_16x16x32_bf16 a[124:127], a[4:7], a[96:99], a[124:127]
    ds_read2_b32 a[28:29], v57 offset0:208 offset1:209
    v_mfma_f32_16x16x32_bf16 a[124:127], a[8:11], a[72:75], a[124:127]
    ds_read_b128 v[76:79], v51 offset:1536
    v_mfma_f32_16x16x32_bf16 a[124:127], a[12:15], a[92:95], a[124:127]
    v_cvt_pk_bf16_f32 v80, v120, v24
    v_cvt_pk_bf16_f32 v81, v121, v25
    v_mfma_f32_16x16x32_bf16 a[124:127], v[84:87], v[36:39], a[124:127]
    v_cvt_pk_bf16_f32 v82, v122, v26
    v_cvt_pk_bf16_f32 v83, v123, v27
    v_mfma_f32_16x16x32_bf16 a[124:127], v[124:127], v[16:19], a[124:127]
    ds_read_b128 v[28:31], v51 offset:1552
    s_waitcnt lgkmcnt(7)
    v_mfma_f32_16x16x32_bf16 a[124:127], v[100:103], v[116:119], a[124:127]
    v_mfma_f32_16x16x32_bf16 a[124:127], a[16:19], a[68:71], a[124:127]
    v_mfma_f32_16x16x32_bf16 a[124:127], a[20:23], a[88:91], a[124:127]
    s_waitcnt lgkmcnt(5)
    v_mfma_f32_16x16x32_bf16 a[124:127], a[24:27], a[64:67], a[124:127]
    s_waitcnt lgkmcnt(2)
    v_mfma_f32_16x16x32_bf16 a[124:127], a[28:31], a[84:87], a[124:127]
    v_mfma_f32_16x16x32_bf16 a[104:107], a[0:3], a[80:83], 0
    ds_read2_b32 v[94:95], v54 offset0:42 offset1:43
    v_mfma_f32_16x16x32_bf16 a[104:107], a[4:7], a[100:103], a[104:107]
    ds_read2_b32 v[92:93], v54 offset0:40 offset1:41
    s_waitcnt lgkmcnt(3)
    v_mfma_f32_16x16x32_bf16 v[96:99], v[76:79], v[68:71], 0
    ds_read2_b32 a[34:35], v58 offset0:2 offset1:3
    s_waitcnt lgkmcnt(3)
    v_mfma_f32_16x16x32_bf16 v[104:107], v[28:31], v[72:75], 0
    ds_write_b128 v49, a[124:127] offset:45056
    v_mfma_f32_16x16x32_bf16 a[104:107], a[8:11], a[76:79], a[104:107]
    ds_read2_b32 a[32:33], v58 offset0:0 offset1:1
    v_mfma_f32_16x16x32_bf16 a[104:107], a[12:15], a[96:99], a[104:107]
    ds_read2_b32 a[38:39], v58 offset0:18 offset1:19
    v_mfma_f32_16x16x32_bf16 a[104:107], a[16:19], a[72:75], a[104:107]
    ds_read2_b32 a[36:37], v58 offset0:16 offset1:17
    v_mfma_f32_16x16x32_bf16 a[104:107], a[20:23], a[92:95], a[104:107]
    s_waitcnt lgkmcnt(3)
    s_barrier
    v_cvt_pk_bf16_f32 v32, v96, v104
    v_cvt_pk_bf16_f32 v33, v97, v105
    v_mfma_f32_16x16x32_bf16 a[104:107], v[84:87], v[88:91], a[104:107]
    v_cvt_pk_bf16_f32 v34, v98, v106
    v_cvt_pk_bf16_f32 v35, v99, v107
    v_mfma_f32_16x16x32_bf16 a[104:107], v[124:127], v[20:23], a[104:107]
    ds_read_b128 v[112:115], v50 offset:2560
    v_mfma_f32_16x16x32_bf16 a[104:107], v[80:83], v[12:15], a[104:107]
    v_mfma_f32_16x16x32_bf16 a[104:107], v[100:103], v[92:95], a[104:107]
    v_mfma_f32_16x16x32_bf16 a[104:107], a[24:27], a[68:71], a[104:107]
    v_mfma_f32_16x16x32_bf16 a[104:107], a[28:31], a[88:91], a[104:107]
    s_waitcnt lgkmcnt(3)
    v_mfma_f32_16x16x32_bf16 a[104:107], a[32:35], a[64:67], a[104:107]
    s_waitcnt lgkmcnt(1)
    v_mfma_f32_16x16x32_bf16 a[104:107], a[36:39], a[84:87], a[104:107]
    ds_read2_b32 v[26:27], v54 offset0:34 offset1:35
    v_mfma_f32_16x16x32_bf16 a[108:111], a[8:11], a[80:83], 0
    ds_read2_b32 v[24:25], v54 offset0:32 offset1:33
    v_mfma_f32_16x16x32_bf16 a[108:111], a[12:15], a[100:103], a[108:111]
    ds_read2_b32 a[42:43], v58 offset0:66 offset1:67
    s_waitcnt lgkmcnt(3)
    v_mfma_f32_16x16x32_bf16 v[120:123], v[112:115], v[60:63], 0
    ds_read2_b32 a[40:41], v58 offset0:64 offset1:65
    v_mfma_f32_16x16x32_bf16 v[76:79], v[112:115], v[64:67], 0
    ds_write_b128 v49, a[104:107] offset:49152
    v_mfma_f32_16x16x32_bf16 a[108:111], a[16:19], a[76:79], a[108:111]
    ds_read2_b32 a[46:47], v58 offset0:82 offset1:83
    v_mfma_f32_16x16x32_bf16 a[108:111], a[20:23], a[96:99], a[108:111]
    ds_read2_b32 a[44:45], v58 offset0:80 offset1:81
    v_mfma_f32_16x16x32_bf16 a[108:111], a[24:27], a[72:75], a[108:111]
    v_mfma_f32_16x16x32_bf16 a[108:111], a[28:31], a[92:95], a[108:111]
    s_nop 0
    v_cvt_pk_bf16_f32 v28, v120, v76
    v_cvt_pk_bf16_f32 v29, v121, v77
    v_mfma_f32_16x16x32_bf16 a[108:111], v[124:127], v[36:39], a[108:111]
    v_cvt_pk_bf16_f32 v30, v122, v78
    v_cvt_pk_bf16_f32 v31, v123, v79
    v_mfma_f32_16x16x32_bf16 a[108:111], v[80:83], v[16:19], a[108:111]
    s_waitcnt lgkmcnt(5)
    v_mfma_f32_16x16x32_bf16 a[108:111], v[100:103], v[24:27], a[108:111]
    v_mfma_f32_16x16x32_bf16 a[108:111], a[32:35], a[68:71], a[108:111]
    v_mfma_f32_16x16x32_bf16 a[108:111], a[36:39], a[88:91], a[108:111]
    s_waitcnt lgkmcnt(3)
    v_mfma_f32_16x16x32_bf16 a[108:111], a[40:43], a[64:67], a[108:111]
    s_waitcnt lgkmcnt(0)
    v_mfma_f32_16x16x32_bf16 a[108:111], a[44:47], a[84:87], a[108:111]
    ds_read2_b32 v[86:87], v54 offset0:26 offset1:27
    v_mfma_f32_16x16x32_bf16 a[112:115], a[16:19], a[80:83], 0
    ds_read2_b32 v[84:85], v54 offset0:24 offset1:25
    v_mfma_f32_16x16x32_bf16 a[112:115], a[20:23], a[100:103], a[112:115]
    ds_read2_b32 a[50:51], v58 offset0:130 offset1:131
    v_mfma_f32_16x16x32_bf16 a[112:115], a[24:27], a[76:79], a[112:115]
    ds_read2_b32 a[48:49], v58 offset0:128 offset1:129
    v_mfma_f32_16x16x32_bf16 a[112:115], a[28:31], a[96:99], a[112:115]
    ds_write_b128 v49, a[108:111] offset:53248
    v_mfma_f32_16x16x32_bf16 a[112:115], a[32:35], a[72:75], a[112:115]
    ds_read2_b32 a[54:55], v58 offset0:146 offset1:147
    v_mfma_f32_16x16x32_bf16 a[112:115], a[36:39], a[92:95], a[112:115]
    ds_read2_b32 a[52:53], v58 offset0:144 offset1:145
    v_mfma_f32_16x16x32_bf16 a[112:115], v[124:127], v[88:91], a[112:115]
    v_mfma_f32_16x16x32_bf16 a[112:115], v[80:83], v[20:23], a[112:115]
    s_waitcnt lgkmcnt(2)
    s_barrier
    v_mfma_f32_16x16x32_bf16 a[112:115], v[28:31], v[12:15], a[112:115]
    v_mfma_f32_16x16x32_bf16 a[112:115], v[100:103], v[84:87], a[112:115]
    v_mfma_f32_16x16x32_bf16 a[112:115], v[32:35], v[108:111], a[112:115]
    v_mfma_f32_16x16x32_bf16 a[112:115], a[40:43], a[68:71], a[112:115]
    v_mfma_f32_16x16x32_bf16 a[112:115], a[44:47], a[88:91], a[112:115]
    v_mfma_f32_16x16x32_bf16 a[112:115], a[48:51], a[64:67], a[112:115]
    ds_read2_b32 v[98:99], v54 offset0:18 offset1:19
    s_waitcnt lgkmcnt(1)
    v_mfma_f32_16x16x32_bf16 a[112:115], a[52:55], a[84:87], a[112:115]
    ds_read2_b32 v[96:97], v54 offset0:16 offset1:17
    v_mfma_f32_16x16x32_bf16 a[116:119], a[24:27], a[80:83], 0
    ds_read2_b32 a[58:59], v58 offset0:194 offset1:195
    v_mfma_f32_16x16x32_bf16 a[116:119], a[28:31], a[100:103], a[116:119]
    ds_read2_b32 a[56:57], v58 offset0:192 offset1:193
    v_mfma_f32_16x16x32_bf16 a[116:119], a[32:35], a[76:79], a[116:119]
    ds_read2_b32 a[62:63], v58 offset0:210 offset1:211
    v_mfma_f32_16x16x32_bf16 a[116:119], a[36:39], a[96:99], a[116:119]
    ds_write_b128 v49, a[112:115] offset:57344
    v_mfma_f32_16x16x32_bf16 a[116:119], a[40:43], a[72:75], a[116:119]
    ds_read2_b32 a[60:61], v58 offset0:208 offset1:209
    v_mfma_f32_16x16x32_bf16 a[116:119], a[44:47], a[92:95], a[116:119]
    v_mfma_f32_16x16x32_bf16 a[116:119], v[80:83], v[36:39], a[116:119]
    v_mfma_f32_16x16x32_bf16 a[116:119], v[28:31], v[16:19], a[116:119]
    s_waitcnt lgkmcnt(5)
    v_mfma_f32_16x16x32_bf16 a[116:119], v[100:103], v[96:99], a[116:119]
    v_mfma_f32_16x16x32_bf16 a[116:119], v[32:35], v[116:119], a[116:119]
    v_mfma_f32_16x16x32_bf16 a[116:119], a[48:51], a[68:71], a[116:119]
    v_mfma_f32_16x16x32_bf16 a[116:119], a[52:55], a[88:91], a[116:119]
    s_waitcnt lgkmcnt(3)
    v_mfma_f32_16x16x32_bf16 a[116:119], a[56:59], a[64:67], a[116:119]
    s_waitcnt lgkmcnt(0)
    v_mfma_f32_16x16x32_bf16 a[116:119], a[60:63], a[84:87], a[116:119]
    s_nop 7
    ds_write_b128 v49, a[116:119] offset:61440
    s_waitcnt lgkmcnt(0)
    s_barrier
L_end:
    s_endpgm
.p2align 6
L_tm:
    s_branch L_tmb
L_m1:
    s_nop 0
    ds_read_b128 a[64:67], v52 offset:64
    ds_read_b128 a[84:87], v52 offset:0
    ds_read_b128 a[68:71], v52 offset:320
    ds_read_b128 a[88:91], v52 offset:256
    ds_read_b128 a[72:75], v52 offset:576
    ds_read_b128 a[92:95], v52 offset:512
    ds_read_b128 a[76:79], v52 offset:832
    ds_read_b128 a[96:99], v52 offset:768
    v_cvt_pk_bf16_f32 v28, v76, v80
    v_cvt_pk_bf16_f32 v29, v77, v81
    v_cvt_pk_bf16_f32 v30, v78, v82
    v_cvt_pk_bf16_f32 v31, v79, v83
    v_cvt_pk_bf16_f32 v32, v84, v88
    v_cvt_pk_bf16_f32 v33, v85, v89
    v_cvt_pk_bf16_f32 v34, v86, v90
    v_cvt_pk_bf16_f32 v35, v87, v91
    v_cvt_pk_bf16_f32 v100, v92, v96
    v_cvt_pk_bf16_f32 v101, v93, v97
    v_cvt_pk_bf16_f32 v102, v94, v98
    v_cvt_pk_bf16_f32 v103, v95, v99
    s_waitcnt lgkmcnt(7)
    v_mfma_f32_16x16x32_bf16 a[104:107], a[0:3], a[64:67], 0
    v_cvt_pk_bf16_f32 v8, v3, v8
    ds_write_b32 v45, v8
    s_waitcnt lgkmcnt(7)
    v_mfma_f32_16x16x32_bf16 a[104:107], a[4:7], a[84:87], a[104:107]
    v_cvt_pk_bf16_f32 v4, v2, v2
    v_cvt_pk_bf16_f32 v5, v117, v117
    s_waitcnt lgkmcnt(6)
    v_mfma_f32_16x16x32_bf16 a[108:111], a[0:3], a[68:71], 0
    v_cvt_pk_bf16_f32 v6, v117, v116
    v_cvt_pk_bf16_f32 v7, v116, v116
    ds_write_b128 v48, v[4:7]
    s_waitcnt lgkmcnt(6)
    v_mfma_f32_16x16x32_bf16 a[108:111], a[4:7], a[88:91], a[108:111]
    v_writelane_b32 v118, 0, 0
    v_cvt_pk_bf16_f32 v3, v120, v120
    v_mfma_f32_16x16x32_bf16 a[108:111], a[8:11], a[64:67], a[108:111]
    v_cvt_pk_bf16_f32 v2, v118, v119
    ds_write_b16 v47, v3
    v_mfma_f32_16x16x32_bf16 a[108:111], a[12:15], a[84:87], a[108:111]
    ds_write_b16 v46, v2 offset:64
    s_waitcnt lgkmcnt(7)
    v_mfma_f32_16x16x32_bf16 a[112:115], a[0:3], a[72:75], 0
    ds_write_b16_d16_hi v46, v2
    s_waitcnt lgkmcnt(7)
    v_mfma_f32_16x16x32_bf16 a[112:115], a[4:7], a[92:95], a[112:115]
    v_mfma_f32_16x16x32_bf16 a[112:115], a[8:11], a[68:71], a[112:115]
    v_mfma_f32_16x16x32_bf16 a[112:115], a[12:15], a[88:91], a[112:115]
    v_mfma_f32_16x16x32_bf16 a[112:115], a[16:19], a[64:67], a[112:115]
    v_mfma_f32_16x16x32_bf16 a[112:115], a[20:23], a[84:87], a[112:115]
    s_waitcnt lgkmcnt(6)
    v_mfma_f32_16x16x32_bf16 a[116:119], a[0:3], a[76:79], 0
    s_waitcnt lgkmcnt(0)
    s_barrier
    ds_read_b128 a[80:83], v52 offset:1088
    ds_read_b128 a[100:103], v52 offset:1024
    v_mfma_f32_16x16x32_bf16 a[116:119], a[4:7], a[96:99], a[116:119]
    v_mfma_f32_16x16x32_bf16 a[116:119], a[8:11], a[72:75], a[116:119]
    ds_write_b128 v49, a[104:107] offset:0
    v_mfma_f32_16x16x32_bf16 a[116:119], a[12:15], a[92:95], a[116:119]
    ds_read2_b32 a[34:35], v56 offset0:2 offset1:3
    v_mfma_f32_16x16x32_bf16 a[116:119], a[16:19], a[68:71], a[116:119]
    ds_read2_b32 a[32:33], v56 offset0:0 offset1:1
    v_mfma_f32_16x16x32_bf16 a[116:119], a[20:23], a[88:91], a[116:119]
    ds_write_b128 v49, a[108:111] offset:4096
    v_mfma_f32_16x16x32_bf16 a[116:119], a[24:27], a[64:67], a[116:119]
    ds_read2_b32 a[38:39], v56 offset0:18 offset1:19
    v_mfma_f32_16x16x32_bf16 a[116:119], a[28:31], a[84:87], a[116:119]
    ds_read2_b32 a[36:37], v56 offset0:16 offset1:17
    s_waitcnt lgkmcnt(7)
    v_mfma_f32_16x16x32_bf16 a[120:123], a[0:3], a[80:83], 0
    ds_write_b128 v49, a[112:115] offset:8192
    s_waitcnt lgkmcnt(7)
    v_mfma_f32_16x16x32_bf16 a[120:123], a[4:7], a[100:103], a[120:123]
    v_mfma_f32_16x16x32_bf16 a[120:123], a[8:11], a[76:79], a[120:123]
    ds_read_b128 v[12:15], v51 offset:1024
    v_mfma_f32_16x16x32_bf16 a[120:123], a[12:15], a[96:99], a[120:123]
    ds_write_b128 v49, a[116:119] offset:12288
    v_mfma_f32_16x16x32_bf16 a[120:123], a[16:19], a[72:75], a[120:123]
    ds_read_b128 v[16:19], v51 offset:1040
    v_mfma_f32_16x16x32_bf16 a[120:123], a[20:23], a[92:95], a[120:123]
    v_mfma_f32_16x16x32_bf16 a[120:123], a[24:27], a[68:71], a[120:123]
    v_mfma_f32_16x16x32_bf16 a[120:123], a[28:31], a[88:91], a[120:123]
    s_waitcnt lgkmcnt(1)
    s_barrier
    ds_read_b64 v[22:23], v53 offset:8
    v_mfma_f32_16x16x32_bf16 a[120:123], a[32:35], a[64:67], a[120:123]
    ds_read_b64 v[20:21], v53 offset:0
    v_mfma_f32_16x16x32_bf16 a[120:123], a[36:39], a[84:87], a[120:123]
    ds_read2_b32 a[42:43], v56 offset0:66 offset1:67
    v_mfma_f32_16x16x32_bf16 a[124:127], a[8:11], a[80:83], 0
    ds_read2_b32 a[40:41], v56 offset0:64 offset1:65
    v_mfma_f32_16x16x32_bf16 a[124:127], a[12:15], a[100:103], a[124:127]
    ds_read2_b32 a[46:47], v56 offset0:82 offset1:83
    v_mfma_f32_16x16x32_bf16 v[24:27], v[12:15], v[68:71], 0
    ds_read2_b32 a[44:45], v56 offset0:80 offset1:81
    s_waitcnt lgkmcnt(6)
    v_mfma_f32_16x16x32_bf16 v[36:39], v[16:19], v[72:75], 0
    ds_write_b128 v49, a[120:123] offset:16384
    v_mfma_f32_16x16x32_bf16 a[124:127], a[16:19], a[76:79], a[124:127]
    v_mfma_f32_16x16x32_bf16 a[124:127], a[20:23], a[96:99], a[124:127]
    v_mfma_f32_16x16x32_bf16 a[124:127], a[24:27], a[72:75], a[124:127]
    v_mfma_f32_16x16x32_bf16 a[124:127], a[28:31], a[92:95], a[124:127]
    s_nop 2
    v_cvt_pk_bf16_f32 v76, v24, v36
    v_cvt_pk_bf16_f32 v77, v25, v37
    s_waitcnt lgkmcnt(5)
    v_mfma_f32_16x16x32_bf16 a[124:127], v[28:31], v[20:23], a[124:127]
    v_cvt_pk_bf16_f32 v78, v26, v38
    v_cvt_pk_bf16_f32 v79, v27, v39
    v_mfma_f32_16x16x32_bf16 a[124:127], a[32:35], a[68:71], a[124:127]
    ds_read_b64 v[82:83], v53 offset:72
    v_mfma_f32_16x16x32_bf16 a[124:127], a[36:39], a[88:91], a[124:127]
    ds_read_b64 v[80:81], v53 offset:64
    s_waitcnt lgkmcnt(5)
    v_mfma_f32_16x16x32_bf16 a[124:127], a[40:43], a[64:67], a[124:127]
    ds_read2_b32 a[50:51], v56 offset0:130 offset1:131
    s_waitcnt lgkmcnt(4)
    v_mfma_f32_16x16x32_bf16 a[124:127], a[44:47], a[84:87], a[124:127]
    ds_read2_b32 a[48:49], v56 offset0:128 offset1:129
    v_mfma_f32_16x16x32_bf16 a[104:107], a[16:19], a[80:83], 0
    ds_read2_b32 a[54:55], v56 offset0:146 offset1:147
    v_mfma_f32_16x16x32_bf16 a[104:107], a[20:23], a[100:103], a[104:107]
    ds_read2_b32 a[52:53], v56 offset0:144 offset1:145
    v_mfma_f32_16x16x32_bf16 a[104:107], a[24:27], a[76:79], a[104:107]
    v_mfma_f32_16x16x32_bf16 a[104:107], a[28:31], a[96:99], a[104:107]
    s_nop 0
    ds_write_b128 v49, a[124:127] offset:20480
    v_mfma_f32_16x16x32_bf16 a[104:107], a[32:35], a[72:75], a[104:107]
    ds_read_b128 v[84:87], v50 offset:1280
    v_mfma_f32_16x16x32_bf16 a[104:107], a[36:39], a[92:95], a[104:107]
    s_waitcnt lgkmcnt(6)
    v_mfma_f32_16x16x32_bf16 a[104:107], v[28:31], v[80:83], a[104:107]
    v_mfma_f32_16x16x32_bf16 a[104:107], a[40:43], a[68:71], a[104:107]
    v_mfma_f32_16x16x32_bf16 a[104:107], a[44:47], a[88:91], a[104:107]
    s_waitcnt lgkmcnt(4)
    v_mfma_f32_16x16x32_bf16 a[104:107], a[48:51], a[64:67], a[104:107]
    ds_read_b64 v[90:91], v53 offset:136
    s_waitcnt lgkmcnt(3)
    v_mfma_f32_16x16x32_bf16 a[104:107], a[52:55], a[84:87], a[104:107]
    ds_read_b64 v[88:89], v53 offset:128
    v_mfma_f32_16x16x32_bf16 a[108:111], a[24:27], a[80:83], 0
    ds_read2_b32 a[58:59], v56 offset0:194 offset1:195
    v_mfma_f32_16x16x32_bf16 a[108:111], a[28:31], a[100:103], a[108:111]
    ds_read2_b32 a[56:57], v56 offset0:192 offset1:193
    s_waitcnt lgkmcnt(4)
    v_mfma_f32_16x16x32_bf16 v[92:95], v[84:87], v[60:63], 0
    ds_read2_b32 a[62:63], v56 offset0:210 offset1:211
    v_mfma_f32_16x16x32_bf16 v[96:99], v[84:87], v[64:67], 0
    ds_write_b128 v49, a[104:107] offset:24576
    v_mfma_f32_16x16x32_bf16 a[108:111], a[32:35], a[76:79], a[108:111]
    ds_read2_b32 a[60:61], v56 offset0:208 offset1:209
    v_mfma_f32_16x16x32_bf16 a[108:111], a[36:39], a[96:99], a[108:111]
    v_mfma_f32_16x16x32_bf16 a[108:111], a[40:43], a[72:75], a[108:111]
    v_mfma_f32_16x16x32_bf16 a[108:111], a[44:47], a[92:95], a[108:111]
    s_nop 1
    v_cvt_pk_bf16_f32 v104, v92, v96
    v_cvt_pk_bf16_f32 v105, v93, v97
    s_waitcnt lgkmcnt(5)
    v_mfma_f32_16x16x32_bf16 a[108:111], v[28:31], v[88:91], a[108:111]
    v_cvt_pk_bf16_f32 v106, v94, v98
    v_cvt_pk_bf16_f32 v107, v95, v99
    v_mfma_f32_16x16x32_bf16 a[108:111], v[32:35], v[20:23], a[108:111]
    v_mfma_f32_16x16x32_bf16 a[108:111], a[48:51], a[68:71], a[108:111]
    ds_read_b64 v[126:127], v53 offset:200
    v_mfma_f32_16x16x32_bf16 a[108:111], a[52:55], a[88:91], a[108:111]
    ds_read_b64 v[124:125], v53 offset:192
    s_waitcnt lgkmcnt(5)
    v_mfma_f32_16x16x32_bf16 a[108:111], a[56:59], a[64:67], a[108:111]
    ds_read2_b32 v[110:111], v54 offset0:58 offset1:59
    s_waitcnt lgkmcnt(3)
    v_mfma_f32_16x16x32_bf16 a[108:111], a[60:63], a[84:87], a[108:111]
    ds_read2_b32 v[108:109], v54 offset0:56 offset1:57
    v_mfma_f32_16x16x32_bf16 a[112:115], a[32:35], a[80:83], 0
    v_mfma_f32_16x16x32_bf16 a[112:115], a[36:39], a[100:103], a[112:115]
    v_mfma_f32_16x16x32_bf16 a[112:115], a[40:43], a[76:79], a[112:115]
    v_mfma_f32_16x16x32_bf16 a[112:115], a[44:47], a[96:99], a[112:115]
    s_nop 2
    ds_write_b128 v49, a[108:111] offset:28672
    v_mfma_f32_16x16x32_bf16 a[112:115], a[48:51], a[72:75], a[112:115]
    v_mfma_f32_16x16x32_bf16 a[112:115], a[52:55], a[92:95], a[112:115]
    s_waitcnt lgkmcnt(3)
    v_mfma_f32_16x16x32_bf16 a[112:115], v[28:31], v[124:127], a[112:115]
    ds_read_b64 v[114:115], v53 offset:264
    v_mfma_f32_16x16x32_bf16 a[112:115], v[32:35], v[80:83], a[112:115]
    s_waitcnt lgkmcnt(1)
    s_barrier
    ds_read_b64 v[112:113], v53 offset:256
    v_mfma_f32_16x16x32_bf16 a[112:115], v[100:103], v[108:111], a[112:115]
    ds_read2_b32 v[118:119], v54 offset0:50 offset1:51
    v_mfma_f32_16x16x32_bf16 a[112:115], a[56:59], a[68:71], a[112:115]
    ds_read2_b32 v[116:117], v54 offset0:48 offset1:49
    v_mfma_f32_16x16x32_bf16 a[112:115], a[60:63], a[88:91], a[112:115]
    ds_read2_b32 a[2:3], v57 offset0:2 offset1:3
    v_mfma_f32_16x16x32_bf16 a[116:119], a[40:43], a[80:83], 0
    ds_read2_b32 a[0:1], v57 offset0:0 offset1:1
    v_mfma_f32_16x16x32_bf16 a[116:119], a[44:47], a[100:103], a[116:119]
    ds_read2_b32 a[6:7], v57 offset0:18 offset1:19
    v_mfma_f32_16x16x32_bf16 a[116:119], a[48:51], a[76:79], a[116:119]
    ds_read2_b32 a[4:5], v57 offset0:16 offset1:17
    v_mfma_f32_16x16x32_bf16 a[116:119], a[52:55], a[96:99], a[116:119]
    ds_read2_b32 a[10:11], v57 offset0:66 offset1:67
    v_mfma_f32_16x16x32_bf16 a[116:119], a[56:59], a[72:75], a[116:119]
    ds_read2_b32 a[8:9], v57 offset0:64 offset1:65
    v_mfma_f32_16x16x32_bf16 a[116:119], a[60:63], a[92:95], a[116:119]
    ds_read2_b32 a[14:15], v57 offset0:82 offset1:83
    s_waitcnt lgkmcnt(9)
    v_mfma_f32_16x16x32_bf16 a[116:119], v[28:31], v[112:115], a[116:119]
    ds_read2_b32 a[12:13], v57 offset0:80 offset1:81
    v_mfma_f32_16x16x32_bf16 a[116:119], v[32:35], v[88:91], a[116:119]
    v_mfma_f32_16x16x32_bf16 a[116:119], v[104:107], v[20:23], a[116:119]
    s_waitcnt lgkmcnt(8)
    v_mfma_f32_16x16x32_bf16 a[116:119], v[100:103], v[116:119], a[116:119]
    ds_read_b128 v[120:123], v50 offset:1792
    s_waitcnt lgkmcnt(7)
    v_mfma_f32_16x16x32_bf16 a[112:115], a[0:3], a[64:67], a[112:115]
    s_waitcnt lgkmcnt(5)
    v_mfma_f32_16x16x32_bf16 a[112:115], a[4:7], a[84:87], a[112:115]
    v_mfma_f32_16x16x32_bf16 a[116:119], a[0:3], a[68:71], a[116:119]
    v_mfma_f32_16x16x32_bf16 a[116:119], a[4:7], a[88:91], a[116:119]
    s_waitcnt lgkmcnt(3)
    v_mfma_f32_16x16x32_bf16 a[116:119], a[8:11], a[64:67], a[116:119]
    ds_read2_b32 v[14:15], v54 offset0:42 offset1:43
    s_waitcnt lgkmcnt(2)
    v_mfma_f32_16x16x32_bf16 a[116:119], a[12:15], a[84:87], a[116:119]
    s_nop 0
    ds_write_b128 v49, a[112:115] offset:32768
    v_mfma_f32_16x16x32_bf16 a[120:123], a[48:51], a[80:83], 0
    ds_read2_b32 v[12:13], v54 offset0:40 offset1:41
    v_mfma_f32_16x16x32_bf16 a[120:123], a[52:55], a[100:103], a[120:123]
    ds_read2_b32 a[18:19], v57 offset0:130 offset1:131
    s_waitcnt lgkmcnt(4)
    v_mfma_f32_16x16x32_bf16 v[16:19], v[120:123], v[60:63], 0
    ds_read2_b32 a[16:17], v57 offset0:128 offset1:129
    v_mfma_f32_16x16x32_bf16 v[24:27], v[120:123], v[64:67], 0
    ds_write_b128 v49, a[116:119] offset:36864
    v_mfma_f32_16x16x32_bf16 a[120:123], a[56:59], a[76:79], a[120:123]
    ds_read2_b32 a[22:23], v57 offset0:146 offset1:147
    v_mfma_f32_16x16x32_bf16 a[120:123], a[60:63], a[96:99], a[120:123]
    ds_read2_b32 a[20:21], v57 offset0:144 offset1:145
    v_mfma_f32_16x16x32_bf16 a[120:123], a[0:3], a[72:75], a[120:123]
    v_mfma_f32_16x16x32_bf16 a[120:123], a[4:7], a[92:95], a[120:123]
    s_waitcnt lgkmcnt(2)
    s_barrier
    v_cvt_pk_bf16_f32 v36, v16, v24
    v_cvt_pk_bf16_f32 v37, v17, v25
    v_mfma_f32_16x16x32_bf16 a[120:123], v[32:35], v[124:127], a[120:123]
    v_cvt_pk_bf16_f32 v38, v18, v26
    v_cvt_pk_bf16_f32 v39, v19, v27
    v_mfma_f32_16x16x32_bf16 a[120:123], v[104:107], v[80:83], a[120:123]
    v_mfma_f32_16x16x32_bf16 a[120:123], v[100:103], v[12:15], a[120:123]
    v_mfma_f32_16x16x32_bf16 a[120:123], a[8:11], a[68:71], a[120:123]
    v_mfma_f32_16x16x32_bf16 a[120:123], a[12:15], a[88:91], a[120:123]
    v_mfma_f32_16x16x32_bf16 a[120:123], a[16:19], a[64:67], a[120:123]
    ds_read2_b32 v[86:87], v54 offset0:34 offset1:35
    s_waitcnt lgkmcnt(1)
    v_mfma_f32_16x16x32_bf16 a[120:123], a[20:23], a[84:87], a[120:123]
    ds_read2_b32 v[84:85], v54 offset0:32 offset1:33
    v_mfma_f32_16x16x32_bf16 a[124:127], a[56:59], a[80:83], 0
    ds_read2_b32 a[26:27], v57 offset0:194 offset1:195
    v_mfma_f32_16x16x32_bf16 a[124:127], a[60:63], a[100:103], a[124:127]
    ds_read2_b32 a[24:25], v57 offset0:192 offset1:193
    v_mfma_f32_16x16x32_bf16 a[124:127], a[0:3], a[76:79], a[124:127]
    ds_read2_b32 a[30:31], v57 offset0:210 offset1:211
    v_mfma_f32_16x16x32_bf16 a[124:127], a[4:7], a[96:99], a[124:127]
    ds_write_b128 v49, a[120:123] offset:40960
    v_mfma_f32_16x16x32_bf16 a[124:127], a[8:11], a[72:75], a[124:127]
    ds_read2_b32 a[28:29], v57 offset0:208 offset1:209
    v_mfma_f32_16x16x32_bf16 a[124:127], a[12:15], a[92:95], a[124:127]
    v_mfma_f32_16x16x32_bf16 a[124:127], v[32:35], v[112:115], a[124:127]
    v_mfma_f32_16x16x32_bf16 a[124:127], v[104:107], v[88:91], a[124:127]
    ds_read_b128 v[92:95], v50 offset:2304
    v_mfma_f32_16x16x32_bf16 a[124:127], v[36:39], v[20:23], a[124:127]
    s_waitcnt lgkmcnt(6)
    v_mfma_f32_16x16x32_bf16 a[124:127], v[100:103], v[84:87], a[124:127]
    v_mfma_f32_16x16x32_bf16 a[124:127], a[16:19], a[68:71], a[124:127]
    v_mfma_f32_16x16x32_bf16 a[124:127], a[20:23], a[88:91], a[124:127]
    s_waitcnt lgkmcnt(4)
    v_mfma_f32_16x16x32_bf16 a[124:127], a[24:27], a[64:67], a[124:127]
    s_waitcnt lgkmcnt(1)
    v_mfma_f32_16x16x32_bf16 a[124:127], a[28:31], a[84:87], a[124:127]
    v_mfma_f32_16x16x32_bf16 a[104:107], a[0:3], a[80:83], 0
    ds_read2_b32 v[98:99], v54 offset0:26 offset1:27
    v_mfma_f32_16x16x32_bf16 a[104:107], a[4:7], a[100:103], a[104:107]
    ds_read2_b32 v[96:97], v54 offset0:24 offset1:25
    s_waitcnt lgkmcnt(2)
    v_mfma_f32_16x16x32_bf16 v[28:31], v[92:95], v[60:63], 0
    ds_read2_b32 a[34:35], v58 offset0:2 offset1:3
    v_mfma_f32_16x16x32_bf16 v[120:123], v[92:95], v[64:67], 0
    ds_write_b128 v49, a[124:127] offset:45056
    v_mfma_f32_16x16x32_bf16 a[104:107], a[8:11], a[76:79], a[104:107]
    ds_read2_b32 a[32:33], v58 offset0:0 offset1:1
    v_mfma_f32_16x16x32_bf16 a[104:107], a[12:15], a[96:99], a[104:107]
    ds_read2_b32 a[38:39], v58 offset0:18 offset1:19
    v_mfma_f32_16x16x32_bf16 a[104:107], a[16:19], a[72:75], a[104:107]
    ds_read2_b32 a[36:37], v58 offset0:16 offset1:17
    v_mfma_f32_16x16x32_bf16 a[104:107], a[20:23], a[92:95], a[104:107]
    s_waitcnt lgkmcnt(3)
    s_barrier
    v_cvt_pk_bf16_f32 v16, v28, v120
    v_cvt_pk_bf16_f32 v17, v29, v121
    v_mfma_f32_16x16x32_bf16 a[104:107], v[104:107], v[124:127], a[104:107]
    v_cvt_pk_bf16_f32 v18, v30, v122
    v_cvt_pk_bf16_f32 v19, v31, v123
    v_mfma_f32_16x16x32_bf16 a[104:107], v[36:39], v[80:83], a[104:107]
    v_mfma_f32_16x16x32_bf16 a[104:107], v[100:103], v[96:99], a[104:107]
    v_mfma_f32_16x16x32_bf16 a[104:107], v[76:79], v[108:111], a[104:107]
    v_mfma_f32_16x16x32_bf16 a[104:107], a[24:27], a[68:71], a[104:107]
    v_mfma_f32_16x16x32_bf16 a[104:107], a[28:31], a[88:91], a[104:107]
    s_waitcnt lgkmcnt(2)
    v_mfma_f32_16x16x32_bf16 a[104:107], a[32:35], a[64:67], a[104:107]
    s_waitcnt lgkmcnt(0)
    v_mfma_f32_16x16x32_bf16 a[104:107], a[36:39], a[84:87], a[104:107]
    ds_read2_b32 v[26:27], v54 offset0:18 offset1:19
    v_mfma_f32_16x16x32_bf16 a[108:111], a[8:11], a[80:83], 0
    ds_read2_b32 v[24:25], v54 offset0:16 offset1:17
    v_mfma_f32_16x16x32_bf16 a[108:111], a[12:15], a[100:103], a[108:111]
    ds_read2_b32 a[42:43], v58 offset0:66 offset1:67
    v_mfma_f32_16x16x32_bf16 a[108:111], a[16:19], a[76:79], a[108:111]
    ds_read2_b32 a[40:41], v58 offset0:64 offset1:65
    v_mfma_f32_16x16x32_bf16 a[108:111], a[20:23], a[96:99], a[108:111]
    ds_write_b128 v49, a[104:107] offset:49152
    v_mfma_f32_16x16x32_bf16 a[108:111], a[24:27], a[72:75], a[108:111]
    ds_read2_b32 a[46:47], v58 offset0:82 offset1:83
    v_mfma_f32_16x16x32_bf16 a[108:111], a[28:31], a[92:95], a[108:111]
    ds_read2_b32 a[44:45], v58 offset0:80 offset1:81
    v_mfma_f32_16x16x32_bf16 a[108:111], v[104:107], v[112:115], a[108:111]
    v_mfma_f32_16x16x32_bf16 a[108:111], v[36:39], v[88:91], a[108:111]
    v_mfma_f32_16x16x32_bf16 a[108:111], v[16:19], v[20:23], a[108:111]
    ds_read_b128 v[32:35], v50 offset:2816
    s_waitcnt lgkmcnt(6)
    v_mfma_f32_16x16x32_bf16 a[108:111], v[100:103], v[24:27], a[108:111]
    v_mfma_f32_16x16x32_bf16 a[108:111], v[76:79], v[116:119], a[108:111]
    v_mfma_f32_16x16x32_bf16 a[108:111], a[32:35], a[68:71], a[108:111]
    v_mfma_f32_16x16x32_bf16 a[108:111], a[36:39], a[88:91], a[108:111]
    s_waitcnt lgkmcnt(4)
    v_mfma_f32_16x16x32_bf16 a[108:111], a[40:43], a[64:67], a[108:111]
    s_waitcnt lgkmcnt(1)
    v_mfma_f32_16x16x32_bf16 a[108:111], a[44:47], a[84:87], a[108:111]
    v_mfma_f32_16x16x32_bf16 a[112:115], a[16:19], a[80:83], 0
    ds_read2_b32 v[94:95], v54 offset0:10 offset1:11
    v_mfma_f32_16x16x32_bf16 a[112:115], a[20:23], a[100:103], a[112:115]
    ds_read2_b32 v[92:93], v54 offset0:8 offset1:9
    s_waitcnt lgkmcnt(2)
    v_mfma_f32_16x16x32_bf16 v[28:31], v[32:35], v[60:63], 0
    ds_read2_b32 a[50:51], v58 offset0:130 offset1:131
    v_mfma_f32_16x16x32_bf16 v[120:123], v[32:35], v[64:67], 0
    ds_write_b128 v49, a[108:111] offset:53248
    v_mfma_f32_16x16x32_bf16 a[112:115], a[24:27], a[76:79], a[112:115]
    ds_read2_b32 a[48:49], v58 offset0:128 offset1:129
    v_mfma_f32_16x16x32_bf16 a[112:115], a[28:31], a[96:99], a[112:115]
    ds_read2_b32 a[54:55], v58 offset0:146 offset1:147
    v_mfma_f32_16x16x32_bf16 a[112:115], a[32:35], a[72:75], a[112:115]
    ds_read2_b32 a[52:53], v58 offset0:144 offset1:145
    v_mfma_f32_16x16x32_bf16 a[112:115], a[36:39], a[92:95], a[112:115]
    s_waitcnt lgkmcnt(3)
    s_barrier
    v_cvt_pk_bf16_f32 v96, v28, v120
    v_cvt_pk_bf16_f32 v97, v29, v121
    v_mfma_f32_16x16x32_bf16 a[112:115], v[36:39], v[124:127], a[112:115]
    v_cvt_pk_bf16_f32 v98, v30, v122
    v_cvt_pk_bf16_f32 v99, v31, v123
    v_mfma_f32_16x16x32_bf16 a[112:115], v[16:19], v[80:83], a[112:115]
    v_mfma_f32_16x16x32_bf16 a[112:115], v[100:103], v[92:95], a[112:115]
    v_mfma_f32_16x16x32_bf16 a[112:115], v[76:79], v[12:15], a[112:115]
    v_mfma_f32_16x16x32_bf16 a[112:115], a[40:43], a[68:71], a[112:115]
    v_mfma_f32_16x16x32_bf16 a[112:115], a[44:47], a[88:91], a[112:115]
    s_waitcnt lgkmcnt(2)
    v_mfma_f32_16x16x32_bf16 a[112:115], a[48:51], a[64:67], a[112:115]
    s_waitcnt lgkmcnt(0)
    v_mfma_f32_16x16x32_bf16 a[112:115], a[52:55], a[84:87], a[112:115]
    ds_read2_b32 v[110:111], v54 offset0:2 offset1:3
    v_mfma_f32_16x16x32_bf16 a[116:119], a[24:27], a[80:83], 0
    ds_read2_b32 v[108:109], v54 offset0:0 offset1:1
    v_mfma_f32_16x16x32_bf16 a[116:119], a[28:31], a[100:103], a[116:119]
    ds_read2_b32 a[58:59], v58 offset0:194 offset1:195
    v_mfma_f32_16x16x32_bf16 a[116:119], a[32:35], a[76:79], a[116:119]
    ds_read2_b32 a[56:57], v58 offset0:192 offset1:193
    v_mfma_f32_16x16x32_bf16 a[116:119], a[36:39], a[96:99], a[116:119]
    ds_write_b128 v49, a[112:115] offset:57344
    v_mfma_f32_16x16x32_bf16 a[116:119], a[40:43], a[72:75], a[116:119]
    ds_read2_b32 a[62:63], v58 offset0:210 offset1:211
    v_mfma_f32_16x16x32_bf16 a[116:119], a[44:47], a[92:95], a[116:119]
    ds_read2_b32 a[60:61], v58 offset0:208 offset1:209
    v_mfma_f32_16x16x32_bf16 a[116:119], v[36:39], v[112:115], a[116:119]
    v_mfma_f32_16x16x32_bf16 a[116:119], v[16:19], v[88:91], a[116:119]
    v_mfma_f32_16x16x32_bf16 a[116:119], v[96:99], v[20:23], a[116:119]
    s_waitcnt lgkmcnt(5)
    v_mfma_f32_16x16x32_bf16 a[116:119], v[100:103], v[108:111], a[116:119]
    v_mfma_f32_16x16x32_bf16 a[116:119], v[76:79], v[84:87], a[116:119]
    v_mfma_f32_16x16x32_bf16 a[116:119], a[48:51], a[68:71], a[116:119]
    v_mfma_f32_16x16x32_bf16 a[116:119], a[52:55], a[88:91], a[116:119]
    s_waitcnt lgkmcnt(3)
    v_mfma_f32_16x16x32_bf16 a[116:119], a[56:59], a[64:67], a[116:119]
    s_waitcnt lgkmcnt(0)
    v_mfma_f32_16x16x32_bf16 a[116:119], a[60:63], a[84:87], a[116:119]
    s_nop 7
    ds_write_b128 v49, a[116:119] offset:61440
    s_waitcnt lgkmcnt(0)
    s_barrier
    s_endpgm
L_opost:
    s_cmp_lg_u32 s47, 0
    s_cbranch_scc1 L_h1
    s_branch L_tm
L_tmb:
    s_mov_b32 s36, s26
    s_mov_b32 s37, s27
    s_mov_b32 s38, 4210688
    s_mov_b32 s39, 0x20000
    v_mov_b32 v8, 138368
    ds_read_b32 v8, v8
    v_and_b32 v2, 15, v1
    v_lshrrev_b32 v3, 4, v1
    v_and_b32 v4, 7, v2
    v_lshrrev_b32 v5, 3, v2
    v_lshlrev_b32_e64 v6, 4, v4
    v_lshl_add_u32 v6, v3, 2, v6
    v_lshl_add_u32 v7, v5, 1, v6
    s_lshl_b32 s6, s40, 7
    v_add_u32 v7, s6, v7
    v_lshlrev_b32_e64 v49, 2, v7
    s_mov_b32 s32, s22
    s_mov_b32 s33, s23
    s_mov_b32 s34, 2097152
    s_mov_b32 s35, 0x20000
    s_mov_b32 s43, 0x100000
    s_mov_b32 s45, 0x180000
    s_mov_b32 s52, 0x1c0000
    s_mov_b32 s53, 4096
    s_mov_b32 s10, 0
    s_mov_b32 s54, 0
    s_waitcnt lgkmcnt(0)
    v_readfirstlane_b32 s48, v8
    v_lshl_add_u32 v90, v7, 10, s62
    v_lshlrev_b32_e64 v91, 1, v7
    v_add_u32 v91, 115700, v91
    v_lshl_add_u32 v7, v3, 3, v4
    v_lshlrev_b32 v7, 4, v7
    s_lshl_b32 s6, s40, 12
    v_lshl_add_u32 v8, v5, 3, s6
    v_add_u32_e64 v46, v7, v8
    s_and_b32 s57, s40, 1
    s_lshl_b32 s6, s47, 12
    s_lshl_b32 s7, s57, 3
    s_add_u32 s6, s6, s7
    s_add_u32 s6, s6, 57344
    v_lshl_add_u32 v8, v5, 2, s6
    v_add_u32 v47, v7, v8
    s_lshl_b32 s6, s47, 7
    s_lshl_b32 s7, s57, 1
    s_add_u32 s6, s6, s7
    v_add_u32 v6, s6, v6
    v_lshlrev_b32 v50, 2, v6
    v_add_u32 v6, v6, v5
    v_lshlrev_b32 v57, 1, v6
    v_add_u32 v57, 113078, v57
    v_lshl_add_u32 v48, v6, 10, s62
    v_xor_b32 v54, 1, v5
    v_lshlrev_b32 v54, 4, v54
    v_mov_b32 v88, 0
    v_mov_b32 v89, 0
    v_mov_b32 v113, s48
    v_mov_b32 v115, s48
    v_mov_b32 v28, 129948
    s_barrier
    v_lshrrev_b32 v2, 3, v1
    v_and_b32 v3, 7, v1
    v_lshlrev_b32 v53, 5, v3
    v_lshl_add_u32 v53, v2, 2, v53
    s_lshl_b32 s6, s55, 5
    s_lshl_b32 s7, s40, 3
    s_add_u32 s7, s7, s6
    s_lshl_b32 s7, s7, 13
    s_lshl_b32 s56, s58, 8
    s_add_u32 s7, s7, s56
    s_add_u32 s7, s7, 2113536
    v_lshlrev_b32_e64 v4, 13, v2
    v_lshl_add_u32 v4, v3, 4, v4
    v_add_u32_e64 v125, s7, v4
    s_lshl_b32 s7, s58, 0
    s_add_u32 s6, s6, s7
    s_lshl_b32 s7, s6, 13
    s_lshl_b32 s6, s6, 13
    s_add_u32 s6, s6, 16384
    v_lshl_add_u32 v51, v42, 5, s6
    s_lshl_b32 s56, s40, 10
    s_add_u32 s7, s7, s56
    s_add_u32 s7, s7, 2113536
    v_lshl_add_u32 v124, v1, 4, s7
    s_lshr_b32 s6, s58, 2
    s_lshl_b32 s6, s6, 17
    s_and_b32 s7, s58, 3
    s_lshl_b32 s7, s7, 12
    s_add_u32 s6, s6, s7
    s_add_u32 s6, s6, s59
    s_lshl_b32 s7, s40, 5
    s_add_u32 s6, s6, s7
    v_lshlrev_b32_e64 v4, 14, v2
    v_lshl_add_u32 v4, v3, 2, v4
    v_add_u32 v126, s6, v4
    v_lshlrev_b32 v44, 3, v42
    v_add_u32 v44, 113536, v44
    s_waitcnt vmcnt(0)
    s_nop 0
    v_perm_b32 v2, v61, v60, s8
    v_perm_b32 v3, v61, v60, s9
    ds_write_b16 v43, v60 offset:5246
    ds_write_b16_d16_hi v43, v60 offset:13566
    ds_write_b32 v43, v2 offset:1088
    ds_write_b32 v43, v3 offset:9408
    ds_write_b16 v43, v61 offset:5248
    ds_write_b16_d16_hi v43, v61 offset:13568
    s_waitcnt lgkmcnt(0)
    s_barrier
    buffer_load_dwordx2 v[72:73], v49, s[36:39], 0 offen offset:0 sc1
    buffer_load_dwordx4 v[64:67], v51, s[36:39], 0 offen sc1
    buffer_load_dwordx4 v[68:71], v51, s[36:39], 0 offen offset:16 sc1
    buffer_load_dwordx2 v[74:75], v49, s[36:39], 0 offen offset:2048 sc1
    ds_read_b32 v55, v28 offset:0
    ds_read_b32 v62, v28 offset:2688
    ds_read_b32 v56, v28 offset:5120
    ds_read_b32 v63, v28 offset:7808
    ds_read_b32 v16, v91 offset:0
    ds_read_b32 v17, v91 offset:8320
    ds_read_b32 v24, v91 offset:1024
    ds_read_b32 v25, v91 offset:9344
    ds_read_u16_d16_hi v88, v57 offset:0
    ds_read_u16_d16_hi v89, v57 offset:8320
    s_waitcnt lgkmcnt(9)
    v_and_b32 v55, 0xffff0000, v55
    s_waitcnt lgkmcnt(8)
    v_and_b32 v62, 0xffff0000, v62
    v_sub_f32 v55, v55, v62
    s_waitcnt lgkmcnt(7)
    v_and_b32 v56, 0xffff0000, v56
    s_waitcnt lgkmcnt(6)
    v_and_b32 v63, 0xffff0000, v63
    v_sub_f32_e64 v56, v56, v63
    s_barrier
    ds_read2st64_b64 v[92:95], v46 offset0:0 offset1:1
    ds_read2st64_b64 v[96:99], v46 offset0:2 offset1:3
    ds_read2st64_b64 v[100:103], v46 offset0:4 offset1:5
    ds_read2st64_b64 v[104:107], v46 offset0:6 offset1:7
    buffer_load_dwordx2 v[76:77], v49, s[36:39], s53 offen offset:0 sc1
    buffer_load_dwordx2 v[78:79], v49, s[36:39], s53 offen offset:2048 sc1
    buffer_load_dwordx2 v[80:81], v50, s[36:39], s53 offen offset:3072 sc1
    s_waitcnt vmcnt(6)
    v_cmp_ne_u32 vcc, s48, v73
L_chkg00:
    s_nop 3
    s_cbranch_vccnz L_slowg00
L_okg00:
    v_lshlrev_b32_e64 v108, 16, v72
    v_and_b32 v109, 0xffff0000, v72
    s_waitcnt lgkmcnt(2)
    v_add_f32 v92, v92, v96
    v_add_f32 v94, v94, v98
    s_waitcnt lgkmcnt(0)
    v_add_f32 v100, v100, v104
    v_add_f32 v102, v102, v106
    v_sub_f32 v92, v92, v94
    v_sub_f32 v100, v100, v102
    v_fma_f32 v92, v92, v108, v94
    v_fma_f32 v100, v100, v108, v102
    v_cvt_pk_bf16_f32 v112, v92, v100
    v_add_f32 v93, v93, v97
    v_add_f32 v95, v95, v99
    v_add_f32 v101, v101, v105
    v_add_f32 v103, v103, v107
    v_sub_f32 v93, v93, v95
    v_sub_f32 v101, v101, v103
    v_fma_f32 v93, v93, v109, v95
    v_fma_f32 v101, v101, v109, v103
    v_cvt_pk_bf16_f32 v114, v93, v101
    buffer_store_dwordx4 v[112:115], v124, s[36:39], 0 offen sc1
    s_waitcnt vmcnt(5)
    v_xor_b32 v10, s48, v71
L_chku0:
    v_xor_b32 v11, s48, v65
    v_xor_b32 v12, s48, v67
    v_xor_b32_e64 v13, s48, v69
    v_or3_b32 v10, v10, v11, v12
    v_or_b32 v13, v13, v10
    v_cmp_ne_u32 vcc, 0, v13
    s_nop 3
    s_cbranch_vccnz L_slowu0
L_oku0:
    v_perm_b32 v2, v66, v64, s8
    v_perm_b32 v3, v70, v68, s8
    v_perm_b32 v4, v68, v66, s8
    ds_write_b16 v44, v64 offset:4222
    ds_write_b64 v44, v[2:3] offset:64
    ds_write_b32 v44, v4 offset:4224
    ds_write_b16 v44, v70 offset:4228
    v_perm_b32 v2, v66, v64, s9
    v_perm_b32 v3, v70, v68, s9
    v_perm_b32 v4, v68, v66, s9
    ds_write_b16_d16_hi v44, v64 offset:12542
    ds_write_b64 v44, v[2:3] offset:8384
    ds_write_b32 v44, v4 offset:12544
    ds_write_b16_d16_hi v44, v70 offset:12548
    s_waitcnt lgkmcnt(0)
    s_barrier
    ds_read2st64_b64 v[92:95], v46 offset0:32 offset1:33
    ds_read2st64_b64 v[96:99], v46 offset0:34 offset1:35
    ds_read2st64_b64 v[100:103], v46 offset0:36 offset1:37
    ds_read2st64_b64 v[104:107], v46 offset0:38 offset1:39
    s_waitcnt vmcnt(4)
    v_cmp_ne_u32 vcc, s48, v75
L_chkg10:
    s_nop 3
    s_cbranch_vccnz L_slowg10
L_okg10:
    v_lshlrev_b32_e64 v108, 16, v74
    v_and_b32 v109, 0xffff0000, v74
    s_waitcnt lgkmcnt(2)
    v_add_f32 v92, v92, v96
    v_add_f32 v94, v94, v98
    s_waitcnt lgkmcnt(0)
    v_add_f32 v100, v100, v104
    v_add_f32 v102, v102, v106
    v_sub_f32 v92, v92, v94
    v_sub_f32 v100, v100, v102
    v_fma_f32 v92, v92, v108, v94
    v_fma_f32 v100, v100, v108, v102
    v_cvt_pk_bf16_f32 v112, v92, v100
    v_add_f32 v93, v93, v97
    v_add_f32 v95, v95, v99
    v_add_f32 v101, v101, v105
    v_add_f32 v103, v103, v107
    v_sub_f32 v93, v93, v95
    v_sub_f32 v101, v101, v103
    v_fma_f32 v93, v93, v109, v95
    v_fma_f32 v101, v101, v109, v103
    v_cvt_pk_bf16_f32 v114, v93, v101
    buffer_store_dwordx4 v[112:115], v124, s[36:39], s53 offen sc1
    s_waitcnt vmcnt(4)
    v_cmp_ne_u32 vcc, s48, v77
L_chkg20:
    s_nop 3
    s_cbranch_vccnz L_slowg20
L_okg20:
    v_lshlrev_b32_e64 v110, 16, v76
    v_and_b32 v111, 0xffff0000, v76
    v_fma_f32 v120, v110, v55, v62
    v_fma_f32 v121, v111, v55, v62
    v_fma_f32 v122, v110, v56, v63
    v_fma_f32 v123, v111, v56, v63
    v_lshlrev_b32_e64 v18, 16, v16
    v_and_b32 v16, 0xffff0000, v16
    v_lshlrev_b32_e64 v19, 16, v17
    v_and_b32 v17, 0xffff0000, v17
    v_mul_f32 v120, v120, v18
    v_mul_f32 v121, v121, v16
    v_mul_f32 v122, v122, v19
    v_mul_f32_e64 v123, v123, v17
    s_barrier
    ds_read2st64_b64 v[92:95], v46 offset0:64 offset1:65
    ds_read2st64_b64 v[96:99], v46 offset0:66 offset1:67
    ds_read2st64_b64 v[100:103], v46 offset0:68 offset1:69
    ds_read2st64_b64 v[104:107], v46 offset0:70 offset1:71
    s_waitcnt lgkmcnt(2)
    v_add_f32 v92, v92, v96
    v_add_f32 v94, v94, v98
    s_waitcnt lgkmcnt(0)
    v_add_f32 v100, v100, v104
    v_add_f32 v102, v102, v106
    v_sub_f32 v92, v92, v94
    v_sub_f32 v100, v100, v102
    v_sub_f32 v94, v94, v120
    v_sub_f32 v102, v102, v122
    v_fma_f32 v92, v92, v110, v94
    v_fma_f32 v100, v100, v110, v102
    v_cvt_pk_bf16_f32 v6, v92, v100
    buffer_store_dword v6, v90, s[32:35], s43 offen
    v_add_f32 v93, v93, v97
    v_add_f32 v95, v95, v99
    v_add_f32 v101, v101, v105
    v_add_f32 v103, v103, v107
    v_sub_f32 v93, v93, v95
    v_sub_f32 v101, v101, v103
    v_sub_f32 v95, v95, v121
    v_sub_f32 v103, v103, v123
    v_fma_f32 v93, v93, v111, v95
    v_fma_f32 v101, v101, v111, v103
    v_cvt_pk_bf16_f32 v7, v93, v101
    buffer_store_dword v7, v90, s[32:35], s43 offen offset:1024
    s_barrier
    s_waitcnt vmcnt(5)
    v_cmp_ne_u32 vcc, s48, v79
L_chkg30:
    s_nop 3
    s_cbranch_vccnz L_slowg30
L_okg30:
    v_lshlrev_b32 v86, 16, v78
    v_and_b32 v87, 0xffff0000, v78
    v_fma_f32 v20, v86, v55, v62
    v_fma_f32 v21, v87, v55, v62
    v_fma_f32 v22, v86, v56, v63
    v_fma_f32 v23, v87, v56, v63
    v_lshlrev_b32_e64 v26, 16, v24
    v_and_b32 v24, 0xffff0000, v24
    v_lshlrev_b32_e64 v27, 16, v25
    v_and_b32 v25, 0xffff0000, v25
    v_mul_f32 v20, v20, v26
    v_mul_f32 v21, v21, v24
    v_mul_f32 v22, v22, v27
    v_mul_f32 v23, v23, v25
    s_waitcnt vmcnt(4)
    v_cmp_ne_u32 vcc, s48, v81
L_chkg70:
    s_nop 3
    s_cbranch_vccnz L_slowg70
L_okg70:
    v_lshlrev_b32_e64 v30, v54, v80
    v_and_b32 v30, 0xffff0000, v30
    v_fma_f32 v32, v30, v55, v62
    v_fma_f32 v33, v30, v56, v63
    v_mul_f32 v32, v32, v88
    v_mul_f32_e64 v33, v33, v89
    s_barrier
    buffer_load_dwordx4 v[64:67], v125, s[36:39], 0 offen sc1
    buffer_load_dwordx4 v[68:71], v125, s[36:39], 0 offen offset:128 sc1
    ds_read2st64_b64 v[92:95], v46 offset0:96 offset1:97
    ds_read2st64_b64 v[96:99], v46 offset0:98 offset1:99
    ds_read2st64_b64 v[100:103], v46 offset0:100 offset1:101
    ds_read2st64_b64 v[104:107], v46 offset0:102 offset1:103
    s_waitcnt lgkmcnt(2)
    v_add_f32 v92, v92, v96
    v_add_f32 v94, v94, v98
    s_waitcnt lgkmcnt(0)
    v_add_f32 v100, v100, v104
    v_add_f32 v102, v102, v106
    v_sub_f32 v92, v92, v94
    v_sub_f32 v100, v100, v102
    v_sub_f32 v94, v94, v20
    v_sub_f32 v102, v102, v22
    v_fma_f32 v92, v92, v86, v94
    v_fma_f32 v100, v100, v86, v102
    v_cvt_pk_bf16_f32 v8, v92, v100
    buffer_store_dword v8, v90, s[32:35], s45 offen
    v_add_f32 v93, v93, v97
    v_add_f32 v95, v95, v99
    v_add_f32 v101, v101, v105
    v_add_f32 v103, v103, v107
    v_sub_f32 v93, v93, v95
    v_sub_f32 v101, v101, v103
    v_sub_f32 v95, v95, v21
    v_sub_f32 v103, v103, v23
    v_fma_f32 v93, v93, v87, v95
    v_fma_f32 v101, v101, v87, v103
    v_cvt_pk_bf16_f32 v9, v93, v101
    buffer_store_dword v9, v90, s[32:35], s45 offen offset:1024
    s_barrier
    ds_read2st64_b32 v[92:93], v47 offset0:0 offset1:2
    ds_read2st64_b32 v[94:95], v47 offset0:4 offset1:6
    ds_read2st64_b32 v[96:97], v47 offset0:8 offset1:10
    ds_read2st64_b32 v[98:99], v47 offset0:12 offset1:14
    s_waitcnt lgkmcnt(2)
    v_add_f32 v93, v93, v95
    v_add_f32 v92, v92, v94
    s_waitcnt lgkmcnt(0)
    v_add_f32 v97, v97, v99
    v_add_f32 v96, v96, v98
    v_sub_f32 v92, v92, v93
    v_sub_f32 v96, v96, v97
    v_sub_f32 v93, v93, v32
    v_sub_f32_e64 v97, v97, v33
    v_fma_f32 v92, v92, v30, v93
    v_fma_f32 v96, v96, v30, v97
    v_cvt_pk_bf16_f32 v2, v92, v96
    buffer_store_dword v2, v48, s[32:35], s52 offen
    s_waitcnt vmcnt(3)
    v_xor_b32 v10, s48, v71
L_chko0:
    v_xor_b32 v11, s48, v65
    v_xor_b32 v12, s48, v67
    v_xor_b32_e64 v13, s48, v69
    v_or3_b32 v10, v10, v11, v12
    v_or_b32 v13, v13, v10
    v_cmp_ne_u32 vcc, 0, v13
    s_nop 3
    s_cbranch_vccnz L_slowo0
L_oko0:
    ds_bpermute_b32 v116, v53, v64
    ds_bpermute_b32 v117, v53, v66
    ds_bpermute_b32 v118, v53, v68
    ds_bpermute_b32 v119, v53, v70
    s_waitcnt lgkmcnt(3)
    buffer_store_dword v116, v126, s[32:35], 0 offen
    s_waitcnt lgkmcnt(2)
    buffer_store_dword v117, v126, s[32:35], 0 offen offset:1024
    s_waitcnt lgkmcnt(1)
    buffer_store_dword v118, v126, s[32:35], 0 offen offset:2048
    s_waitcnt lgkmcnt(0)
    buffer_store_dword v119, v126, s[32:35], 0 offen offset:3072
    s_or_b32 s55, s2, s40
    s_cmp_lg_u32 s55, 0
    s_cbranch_scc1 L_noep
    v_mov_b32 v2, s48
    v_mov_b32 v3, 8192
    s_mov_b64 exec, 1
    buffer_store_dword v2, v3, s[36:39], 0 offen sc1
    s_mov_b64 exec, -1
L_noep:
    s_endpgm
L_h1:
    s_mov_b32 s36, s26
    s_mov_b32 s37, s27
    s_mov_b32 s38, 4210688
    s_mov_b32 s39, 0x20000
    v_mov_b32 v8, 138368
    ds_read_b32 v8, v8
    v_and_b32 v2, 15, v1
    v_lshrrev_b32 v3, 4, v1
    v_and_b32 v4, 7, v2
    v_lshrrev_b32 v5, 3, v2
    v_lshlrev_b32 v6, 4, v4
    v_lshl_add_u32 v6, v3, 2, v6
    v_lshl_add_u32 v7, v5, 1, v6
    s_lshl_b32 s6, s40, 7
    v_add_u32 v7, s6, v7
    v_lshlrev_b32_e64 v49, 2, v7
    s_mov_b32 s32, s22
    s_mov_b32 s33, s23
    s_mov_b32 s34, 2097152
    s_mov_b32 s35, 0x20000
    s_mov_b32 s43, 0x100000
    s_mov_b32 s45, 0x180000
    s_mov_b32 s52, 0x1c0000
    s_mov_b32 s53, 4096
    s_mov_b32 s10, 0
    s_mov_b32 s54, 0
    s_waitcnt lgkmcnt(0)
    v_readfirstlane_b32 s48, v8
    v_lshl_add_u32 v90, v7, 10, s62
    v_lshlrev_b32_e64 v91, 1, v7
    v_add_u32 v91, 115700, v91
    v_lshl_add_u32 v7, v3, 3, v4
    v_lshlrev_b32 v7, 4, v7
    s_lshl_b32 s6, s40, 12
    v_lshl_add_u32 v8, v5, 3, s6
    v_add_u32_e64 v46, v7, v8
    s_and_b32 s57, s40, 1
    s_lshl_b32 s6, s47, 12
    s_lshl_b32 s7, s57, 3
    s_add_u32 s6, s6, s7
    s_add_u32 s6, s6, 57344
    v_lshl_add_u32 v8, v5, 2, s6
    v_add_u32 v47, v7, v8
    s_lshl_b32 s6, s47, 7
    s_lshl_b32 s7, s57, 1
    s_add_u32 s6, s6, s7
    v_add_u32 v6, s6, v6
    v_lshlrev_b32 v50, 2, v6
    v_add_u32 v6, v6, v5
    v_lshlrev_b32 v57, 1, v6
    v_add_u32 v57, 113078, v57
    v_lshl_add_u32 v48, v6, 10, s62
    v_xor_b32 v54, 1, v5
    v_lshlrev_b32 v54, 4, v54
    v_mov_b32 v88, 0
    v_mov_b32 v89, 0
    v_mov_b32 v113, s48
    v_mov_b32 v115, s48
    v_mov_b32 v28, 129948
    s_barrier
    v_lshrrev_b32 v2, 3, v1
    v_and_b32 v3, 7, v1
    v_lshlrev_b32 v53, 5, v3
    v_lshl_add_u32 v53, v2, 2, v53
    s_lshl_b32 s6, s55, 5
    s_lshl_b32 s7, s40, 3
    s_add_u32 s7, s7, s6
    s_lshl_b32 s7, s7, 13
    s_lshl_b32 s56, s58, 8
    s_add_u32 s7, s7, s56
    s_add_u32 s7, s7, 2113536
    v_lshlrev_b32_e64 v4, 13, v2
    v_lshl_add_u32 v4, v3, 4, v4
    v_add_u32_e64 v125, s7, v4
    s_lshl_b32 s7, s58, 0
    s_add_u32 s6, s6, s7
    s_lshl_b32 s7, s6, 13
    s_lshl_b32 s6, s6, 13
    s_add_u32 s6, s6, 16384
    v_lshl_add_u32 v51, v42, 5, s6
    s_lshl_b32 s56, s40, 10
    s_add_u32 s7, s7, s56
    s_add_u32 s7, s7, 2113536
    v_lshl_add_u32 v124, v1, 4, s7
    s_lshr_b32 s6, s58, 2
    s_lshl_b32 s6, s6, 17
    s_and_b32 s7, s58, 3
    s_lshl_b32 s7, s7, 12
    s_add_u32 s6, s6, s7
    s_add_u32 s6, s6, s59
    s_lshl_b32 s7, s40, 5
    s_add_u32 s6, s6, s7
    v_lshlrev_b32_e64 v4, 14, v2
    v_lshl_add_u32 v4, v3, 2, v4
    v_add_u32 v126, s6, v4
    v_lshlrev_b32 v44, 3, v42
    v_add_u32 v44, 113536, v44
    s_waitcnt vmcnt(0)
    s_nop 0
    v_perm_b32 v2, v61, v60, s8
    v_perm_b32 v3, v61, v60, s9
    ds_write_b16 v43, v60 offset:5246
    ds_write_b16_d16_hi v43, v60 offset:13566
    ds_write_b32 v43, v2 offset:1088
    ds_write_b32 v43, v3 offset:9408
    ds_write_b16 v43, v61 offset:5248
    ds_write_b16_d16_hi v43, v61 offset:13568
    s_waitcnt lgkmcnt(0)
    s_barrier
    buffer_load_dwordx2 v[72:73], v49, s[36:39], 0 offen offset:0 sc1
    buffer_load_dwordx4 v[64:67], v51, s[36:39], 0 offen sc1
    buffer_load_dwordx4 v[68:71], v51, s[36:39], 0 offen offset:16 sc1
    buffer_load_dwordx2 v[74:75], v49, s[36:39], 0 offen offset:2048 sc1
    ds_read_b32 v55, v28 offset:0
    ds_read_b32 v62, v28 offset:2688
    ds_read_b32 v56, v28 offset:5120
    ds_read_b32 v63, v28 offset:7808
    ds_read_b32 v16, v91 offset:0
    ds_read_b32 v17, v91 offset:8320
    ds_read_b32 v24, v91 offset:1024
    ds_read_b32 v25, v91 offset:9344
    ds_read_u16_d16_hi v88, v57 offset:0
    ds_read_u16_d16_hi v89, v57 offset:8320
    s_waitcnt lgkmcnt(9)
    v_and_b32 v55, 0xffff0000, v55
    s_waitcnt lgkmcnt(8)
    v_and_b32 v62, 0xffff0000, v62
    v_sub_f32 v55, v55, v62
    s_waitcnt lgkmcnt(7)
    v_and_b32 v56, 0xffff0000, v56
    s_waitcnt lgkmcnt(6)
    v_and_b32 v63, 0xffff0000, v63
    v_sub_f32_e64 v56, v56, v63
    s_barrier
    ds_read2st64_b64 v[92:95], v46 offset0:0 offset1:1
    ds_read2st64_b64 v[96:99], v46 offset0:2 offset1:3
    ds_read2st64_b64 v[100:103], v46 offset0:4 offset1:5
    ds_read2st64_b64 v[104:107], v46 offset0:6 offset1:7
    buffer_load_dwordx2 v[76:77], v49, s[36:39], s53 offen offset:0 sc1
    buffer_load_dwordx2 v[78:79], v49, s[36:39], s53 offen offset:2048 sc1
    buffer_load_dwordx2 v[80:81], v50, s[36:39], s53 offen offset:3072 sc1
    s_waitcnt vmcnt(6)
    v_cmp_ne_u32 vcc, s48, v73
L_chkg01:
    s_nop 3
    s_cbranch_vccnz L_slowg01
L_okg01:
    v_lshlrev_b32_e64 v108, 16, v72
    v_and_b32 v109, 0xffff0000, v72
    s_waitcnt lgkmcnt(2)
    v_add_f32 v92, v92, v96
    v_add_f32 v94, v94, v98
    s_waitcnt lgkmcnt(0)
    v_add_f32 v100, v100, v104
    v_add_f32 v102, v102, v106
    v_sub_f32 v92, v92, v94
    v_sub_f32 v100, v100, v102
    v_fma_f32 v92, v92, v108, v94
    v_fma_f32 v100, v100, v108, v102
    v_cvt_pk_bf16_f32 v112, v92, v100
    v_add_f32 v93, v93, v97
    v_add_f32 v95, v95, v99
    v_add_f32 v101, v101, v105
    v_add_f32 v103, v103, v107
    v_sub_f32 v93, v93, v95
    v_sub_f32 v101, v101, v103
    v_fma_f32 v93, v93, v109, v95
    v_fma_f32 v101, v101, v109, v103
    v_cvt_pk_bf16_f32 v114, v93, v101
    buffer_store_dwordx4 v[112:115], v124, s[36:39], 0 offen sc1
    s_waitcnt vmcnt(5)
    v_xor_b32 v10, s48, v71
L_chku1:
    v_xor_b32 v11, s48, v65
    v_xor_b32 v12, s48, v67
    v_xor_b32_e64 v13, s48, v69
    v_or3_b32 v10, v10, v11, v12
    v_or_b32 v13, v13, v10
    v_cmp_ne_u32 vcc, 0, v13
    s_nop 3
    s_cbranch_vccnz L_slowu1
L_oku1:
    v_perm_b32 v2, v66, v64, s8
    v_perm_b32 v3, v70, v68, s8
    v_perm_b32 v4, v68, v66, s8
    ds_write_b16 v44, v64 offset:4222
    ds_write_b64 v44, v[2:3] offset:64
    ds_write_b32 v44, v4 offset:4224
    ds_write_b16 v44, v70 offset:4228
    v_perm_b32 v2, v66, v64, s9
    v_perm_b32 v3, v70, v68, s9
    v_perm_b32 v4, v68, v66, s9
    ds_write_b16_d16_hi v44, v64 offset:12542
    ds_write_b64 v44, v[2:3] offset:8384
    ds_write_b32 v44, v4 offset:12544
    ds_write_b16_d16_hi v44, v70 offset:12548
    s_waitcnt lgkmcnt(0)
    s_barrier
    ds_read2st64_b64 v[92:95], v46 offset0:32 offset1:33
    ds_read2st64_b64 v[96:99], v46 offset0:34 offset1:35
    ds_read2st64_b64 v[100:103], v46 offset0:36 offset1:37
    ds_read2st64_b64 v[104:107], v46 offset0:38 offset1:39
    s_waitcnt vmcnt(4)
    v_cmp_ne_u32 vcc, s48, v75
L_chkg11:
    s_nop 3
    s_cbranch_vccnz L_slowg11
L_okg11:
    v_lshlrev_b32_e64 v108, 16, v74
    v_and_b32 v109, 0xffff0000, v74
    s_waitcnt lgkmcnt(2)
    v_add_f32 v92, v92, v96
    v_add_f32 v94, v94, v98
    s_waitcnt lgkmcnt(0)
    v_add_f32 v100, v100, v104
    v_add_f32 v102, v102, v106
    v_sub_f32 v92, v92, v94
    v_sub_f32 v100, v100, v102
    v_fma_f32 v92, v92, v108, v94
    v_fma_f32 v100, v100, v108, v102
    v_cvt_pk_bf16_f32 v112, v92, v100
    v_add_f32 v93, v93, v97
    v_add_f32 v95, v95, v99
    v_add_f32 v101, v101, v105
    v_add_f32 v103, v103, v107
    v_sub_f32 v93, v93, v95
    v_sub_f32 v101, v101, v103
    v_fma_f32 v93, v93, v109, v95
    v_fma_f32 v101, v101, v109, v103
    v_cvt_pk_bf16_f32 v114, v93, v101
    buffer_store_dwordx4 v[112:115], v124, s[36:39], s53 offen sc1
    s_barrier
    s_waitcnt vmcnt(4)
    v_cmp_ne_u32 vcc, s48, v77
L_chkg21:
    s_nop 3
    s_cbranch_vccnz L_slowg21
L_okg21:
    v_lshlrev_b32 v110, 16, v76
    v_and_b32 v111, 0xffff0000, v76
    v_fma_f32 v120, v110, v55, v62
    v_fma_f32 v121, v111, v55, v62
    v_fma_f32 v122, v110, v56, v63
    v_fma_f32 v123, v111, v56, v63
    v_lshlrev_b32_e64 v18, 16, v16
    v_and_b32 v16, 0xffff0000, v16
    v_lshlrev_b32_e64 v19, 16, v17
    v_and_b32 v17, 0xffff0000, v17
    v_mul_f32 v120, v120, v18
    v_mul_f32 v121, v121, v16
    v_mul_f32 v122, v122, v19
    v_mul_f32_e64 v123, v123, v17
    s_barrier
    ds_read2st64_b64 v[92:95], v46 offset0:64 offset1:65
    ds_read2st64_b64 v[96:99], v46 offset0:66 offset1:67
    ds_read2st64_b64 v[100:103], v46 offset0:68 offset1:69
    ds_read2st64_b64 v[104:107], v46 offset0:70 offset1:71
    s_waitcnt lgkmcnt(2)
    v_add_f32 v92, v92, v96
    v_add_f32 v94, v94, v98
    s_waitcnt lgkmcnt(0)
    v_add_f32 v100, v100, v104
    v_add_f32 v102, v102, v106
    v_sub_f32 v92, v92, v94
    v_sub_f32 v100, v100, v102
    v_sub_f32 v94, v94, v120
    v_sub_f32 v102, v102, v122
    v_fma_f32 v92, v92, v110, v94
    v_fma_f32 v100, v100, v110, v102
    v_cvt_pk_bf16_f32 v6, v92, v100
    buffer_store_dword v6, v90, s[32:35], s43 offen
    v_add_f32 v93, v93, v97
    v_add_f32 v95, v95, v99
    v_add_f32 v101, v101, v105
    v_add_f32 v103, v103, v107
    v_sub_f32 v93, v93, v95
    v_sub_f32 v101, v101, v103
    v_sub_f32 v95, v95, v121
    v_sub_f32 v103, v103, v123
    v_fma_f32 v93, v93, v111, v95
    v_fma_f32 v101, v101, v111, v103
    v_cvt_pk_bf16_f32 v7, v93, v101
    buffer_store_dword v7, v90, s[32:35], s43 offen offset:1024
    s_barrier
    buffer_load_dwordx4 v[64:67], v125, s[36:39], 0 offen sc1
    buffer_load_dwordx4 v[68:71], v125, s[36:39], 0 offen offset:128 sc1
    s_waitcnt vmcnt(6)
    v_cmp_ne_u32 vcc, s48, v81
L_chkg71:
    s_nop 3
    s_cbranch_vccnz L_slowg71
L_okg71:
    v_lshlrev_b32 v30, v54, v80
    v_and_b32 v30, 0xffff0000, v30
    v_fma_f32 v32, v30, v55, v62
    v_fma_f32 v33, v30, v56, v63
    v_mul_f32 v32, v32, v88
    v_mul_f32_e64 v33, v33, v89
    s_barrier
    ds_read2st64_b32 v[92:93], v47 offset0:0 offset1:2
    ds_read2st64_b32 v[94:95], v47 offset0:4 offset1:6
    ds_read2st64_b32 v[96:97], v47 offset0:8 offset1:10
    ds_read2st64_b32 v[98:99], v47 offset0:12 offset1:14
    s_waitcnt lgkmcnt(2)
    v_add_f32 v93, v93, v95
    v_add_f32 v92, v92, v94
    s_waitcnt lgkmcnt(0)
    v_add_f32 v97, v97, v99
    v_add_f32 v96, v96, v98
    v_sub_f32 v92, v92, v93
    v_sub_f32 v96, v96, v97
    v_sub_f32 v93, v93, v32
    v_sub_f32 v97, v97, v33
    v_fma_f32 v92, v92, v30, v93
    v_fma_f32 v96, v96, v30, v97
    v_cvt_pk_bf16_f32 v2, v92, v96
    buffer_store_dword v2, v48, s[32:35], s52 offen
    s_waitcnt vmcnt(1)
    v_xor_b32 v10, s48, v71
L_chko1:
    v_xor_b32 v11, s48, v65
    v_xor_b32 v12, s48, v67
    v_xor_b32_e64 v13, s48, v69
    v_or3_b32 v10, v10, v11, v12
    v_or_b32 v13, v13, v10
    v_cmp_ne_u32 vcc, 0, v13
    s_nop 3
    s_cbranch_vccnz L_slowo1
L_oko1:
    ds_bpermute_b32 v116, v53, v64
    ds_bpermute_b32 v117, v53, v66
    ds_bpermute_b32 v118, v53, v68
    ds_bpermute_b32 v119, v53, v70
    s_waitcnt lgkmcnt(3)
    buffer_store_dword v116, v126, s[32:35], 0 offen
    s_waitcnt lgkmcnt(2)
    buffer_store_dword v117, v126, s[32:35], 0 offen offset:1024
    s_waitcnt lgkmcnt(1)
    buffer_store_dword v118, v126, s[32:35], 0 offen offset:2048
    s_waitcnt lgkmcnt(0)
    buffer_store_dword v119, v126, s[32:35], 0 offen offset:3072
    s_endpgm
L_slowg00:
    s_add_u32 s54, s54, 1
    s_cmp_gt_u32 s54, 20000
    s_cbranch_scc1 L_okg00
    s_sleep 8
    buffer_load_dwordx2 v[72:73], v49, s[36:39], 0 offen offset:0 sc1
    s_waitcnt vmcnt(0)
    v_cmp_ne_u32_e64 vcc, s48, v73
    s_nop 4
    s_branch L_chkg00
L_slowu0:
    s_add_u32 s54, s54, 1
    s_cmp_gt_u32 s54, 20000
    s_cbranch_scc1 L_oku0
    s_sleep 2
    buffer_load_dwordx4 v[64:67], v51, s[36:39], 0 offen sc1
    buffer_load_dwordx4 v[68:71], v51, s[36:39], 0 offen offset:16 sc1
    s_waitcnt vmcnt(0)
    v_xor_b32_e64 v10, s48, v71
    s_nop 4
    s_branch L_chku0
L_slowg10:
    s_add_u32 s54, s54, 1
    s_cmp_gt_u32 s54, 20000
    s_cbranch_scc1 L_okg10
    s_sleep 8
    buffer_load_dwordx2 v[74:75], v49, s[36:39], 0 offen offset:2048 sc1
    s_waitcnt vmcnt(0)
    v_cmp_ne_u32_e64 vcc, s48, v75
    s_nop 4
    s_branch L_chkg10
L_slowg20:
    s_add_u32 s54, s54, 1
    s_cmp_gt_u32 s54, 20000
    s_cbranch_scc1 L_okg20
    s_sleep 8
    buffer_load_dwordx2 v[76:77], v49, s[36:39], s53 offen offset:0 sc1
    s_waitcnt vmcnt(0)
    v_cmp_ne_u32_e64 vcc, s48, v77
    s_nop 4
    s_branch L_chkg20
L_slowg30:
    s_add_u32 s54, s54, 1
    s_cmp_gt_u32 s54, 20000
    s_cbranch_scc1 L_okg30
    s_sleep 8
    buffer_load_dwordx2 v[78:79], v49, s[36:39], s53 offen offset:2048 sc1
    s_waitcnt vmcnt(0)
    v_cmp_ne_u32_e64 vcc, s48, v79
    s_nop 4
    s_branch L_chkg30
L_slowg70:
    s_add_u32 s54, s54, 1
    s_cmp_gt_u32 s54, 20000
    s_cbranch_scc1 L_okg70
    s_sleep 8
    buffer_load_dwordx2 v[80:81], v50, s[36:39], s53 offen offset:3072 sc1
    s_waitcnt vmcnt(0)
    v_cmp_ne_u32_e64 vcc, s48, v81
    s_nop 4
    s_branch L_chkg70
L_slowo0:
    s_add_u32 s54, s54, 1
    s_cmp_gt_u32 s54, 20000
    s_cbranch_scc1 L_oko0
    buffer_load_dwordx4 v[64:67], v125, s[36:39], 0 offen sc1
    buffer_load_dwordx4 v[68:71], v125, s[36:39], 0 offen offset:128 sc1
    s_waitcnt vmcnt(0)
    v_xor_b32 v10, s48, v71
    s_nop 4
    s_branch L_chko0
L_slowg01:
    s_add_u32 s54, s54, 1
    s_cmp_gt_u32 s54, 20000
    s_cbranch_scc1 L_okg01
    s_sleep 8
    buffer_load_dwordx2 v[72:73], v49, s[36:39], 0 offen offset:0 sc1
    s_waitcnt vmcnt(0)
    v_cmp_ne_u32_e64 vcc, s48, v73
    s_nop 4
    s_branch L_chkg01
L_slowu1:
    s_add_u32 s54, s54, 1
    s_cmp_gt_u32 s54, 20000
    s_cbranch_scc1 L_oku1
    s_sleep 2
    buffer_load_dwordx4 v[64:67], v51, s[36:39], 0 offen sc1
    buffer_load_dwordx4 v[68:71], v51, s[36:39], 0 offen offset:16 sc1
    s_waitcnt vmcnt(0)
    v_xor_b32_e64 v10, s48, v71
    s_nop 4
    s_branch L_chku1
L_slowg11:
    s_add_u32 s54, s54, 1
    s_cmp_gt_u32 s54, 20000
    s_cbranch_scc1 L_okg11
    s_sleep 8
    buffer_load_dwordx2 v[74:75], v49, s[36:39], 0 offen offset:2048 sc1
    s_waitcnt vmcnt(0)
    v_cmp_ne_u32_e64 vcc, s48, v75
    s_nop 4
    s_branch L_chkg11
L_slowg21:
    s_add_u32 s54, s54, 1
    s_cmp_gt_u32 s54, 20000
    s_cbranch_scc1 L_okg21
    s_sleep 8
    buffer_load_dwordx2 v[76:77], v49, s[36:39], s53 offen offset:0 sc1
    s_waitcnt vmcnt(0)
    v_cmp_ne_u32_e64 vcc, s48, v77
    s_nop 4
    s_branch L_chkg21
L_slowg71:
    s_add_u32 s54, s54, 1
    s_cmp_gt_u32 s54, 20000
    s_cbranch_scc1 L_okg71
    s_sleep 8
    buffer_load_dwordx2 v[80:81], v50, s[36:39], s53 offen offset:3072 sc1
    s_waitcnt vmcnt(0)
    v_cmp_ne_u32_e64 vcc, s48, v81
    s_nop 4
    s_branch L_chkg71
L_slowo1:
    s_add_u32 s54, s54, 1
    s_cmp_gt_u32 s54, 20000
    s_cbranch_scc1 L_oko1
    buffer_load_dwordx4 v[64:67], v125, s[36:39], 0 offen sc1
    buffer_load_dwordx4 v[68:71], v125, s[36:39], 0 offen offset:128 sc1
    s_waitcnt vmcnt(0)
    v_xor_b32 v10, s48, v71
    s_nop 4
    s_branch L_chko1
L_codeend:
.p2align 6
L_wtab:
    .long 0x0, 0x0, 0x0, 0x3f803f80
    .long 0x0, 0x0, 0x0, 0x3f800000
    .long 0x0, 0x0, 0x0, 0x0
    .long 0x0, 0x0, 0x0, 0x0
    .long 0x0, 0x0, 0x0, 0x0
    .long 0x0, 0x0, 0x0, 0x0
    .long 0x0, 0x0, 0x0, 0x0
    .long 0x0, 0x0, 0x0, 0x0
    .long 0x0, 0x0, 0x0, 0x0
    .long 0x0, 0x0, 0x0, 0x0
    .long 0x0, 0x0, 0x0, 0x0
    .long 0x0, 0x0, 0x0, 0x0
    .long 0x0, 0x0, 0x0, 0x0
    .long 0x0, 0x0, 0x0, 0x0
    .long 0x0, 0x0, 0x0, 0x0
    .long 0x0, 0x0, 0x0, 0x0
    .long 0x3f803f80, 0x3f80, 0x0, 0x0
    .long 0x3f803f80, 0x3f803f80, 0x0, 0x0
    .long 0x3f803f80, 0x3f803f80, 0x3f80, 0x0
    .long 0x3f800000, 0x3f803f80, 0x3f803f80, 0x0
    .long 0x0, 0x3f803f80, 0x3f803f80, 0x3f80
    .long 0x0, 0x3f800000, 0x3f803f80, 0x3f803f80
    .long 0x0, 0x0, 0x3f803f80, 0x3f803f80
    .long 0x0, 0x0, 0x3f800000, 0x3f803f80
    .long 0x0, 0x0, 0x0, 0x3f803f80
    .long 0x0, 0x0, 0x0, 0x3f800000
    .long 0x0, 0x0, 0x0, 0x0
    .long 0x0, 0x0, 0x0, 0x0
    .long 0x0, 0x0, 0x0, 0x0
    .long 0x0, 0x0, 0x0, 0x0
    .long 0x0, 0x0, 0x0, 0x0
    .long 0x0, 0x0, 0x0, 0x0
    .long 0x0, 0x0, 0x0, 0x0
    .long 0x0, 0x0, 0x0, 0x0
    .long 0x0, 0x0, 0x0, 0x0
    .long 0x0, 0x0, 0x0, 0x0
    .long 0x0, 0x0, 0x0, 0x0
    .long 0x0, 0x0, 0x0, 0x0
    .long 0x3f80, 0x0, 0x0, 0x0
    .long 0x3f803f80, 0x0, 0x0, 0x0
    .long 0x3f803f80, 0x3f80, 0x0, 0x0
    .long 0x3f803f80, 0x3f803f80, 0x0, 0x0
    .long 0x3f803f80, 0x3f803f80, 0x3f80, 0x0
    .long 0x3f800000, 0x3f803f80, 0x3f803f80, 0x0
    .long 0x0, 0x3f803f80, 0x3f803f80, 0x3f80
    .long 0x0, 0x3f800000, 0x3f803f80, 0x3f803f80
    .long 0x0, 0x0, 0x3f803f80, 0x3f803f80
    .long 0x0, 0x0, 0x3f800000, 0x3f803f80
    .long 0x0, 0x0, 0x0, 0x0
    .long 0x0, 0x0, 0x0, 0x0
    .long 0x0, 0x0, 0x0, 0x0
    .long 0x0, 0x0, 0x0, 0x0
    .long 0x0, 0x0, 0x0, 0x0
    .long 0x0, 0x0, 0x0, 0x0
    .long 0x0, 0x0, 0x0, 0x0
    .long 0x0, 0x0, 0x0, 0x0
    .long 0x0, 0x0, 0x0, 0x0
    .long 0x0, 0x0, 0x0, 0x0
    .long 0x0, 0x0, 0x0, 0x0
    .long 0x0, 0x0, 0x0, 0x0
    .long 0x0, 0x0, 0x0, 0x0
    .long 0x0, 0x0, 0x0, 0x0
    .long 0x3f80, 0x0, 0x0, 0x0
    .long 0x3f803f80, 0x0, 0x0, 0x0
    .long 0x0, 0x3f800000, 0x3f803f80, 0x0
    .long 0x0, 0x0, 0x3f803f80, 0x3f80
    .long 0x0, 0x0, 0x3f800000, 0x3f803f80
    .long 0x0, 0x0, 0x0, 0x3f803f80
    .long 0x0, 0x0, 0x0, 0x3f800000
    .long 0x0, 0x0, 0x0, 0x0
    .long 0x0, 0x0, 0x0, 0x0
    .long 0x0, 0x0, 0x0, 0x0
    .long 0x0, 0x0, 0x0, 0x0
    .long 0x0, 0x0, 0x0, 0x0
    .long 0x0, 0x0, 0x0, 0x0
    .long 0x0, 0x0, 0x0, 0x0
    .long 0x0, 0x0, 0x0, 0x0
    .long 0x0, 0x0, 0x0, 0x0
    .long 0x0, 0x0, 0x0, 0x0
    .long 0x0, 0x0, 0x0, 0x0
    .long 0x0, 0x0, 0x0, 0x0
    .long 0x0, 0x0, 0x0, 0x0
    .long 0x0, 0x0, 0x0, 0x0
    .long 0x3f80, 0x0, 0x0, 0x0
    .long 0x3f803f80, 0x0, 0x0, 0x0
    .long 0x3f803f80, 0x3f80, 0x0, 0x0
    .long 0x3f800000, 0x3f803f80, 0x0, 0x0
    .long 0x0, 0x3f803f80, 0x3f80, 0x0
    .long 0x0, 0x3f800000, 0x3f803f80, 0x0
    .long 0x0, 0x0, 0x3f803f80, 0x3f80
    .long 0x0, 0x0, 0x3f800000, 0x3f803f80
    .long 0x0, 0x0, 0x0, 0x3f803f80
    .long 0x0, 0x0, 0x0, 0x3f800000
    .long 0x0, 0x0, 0x0, 0x0
    .long 0x0, 0x0, 0x0, 0x0
    .long 0x0, 0x0, 0x0, 0x0
    .long 0x0, 0x0, 0x0, 0x0
    .long 0x0, 0x0, 0x0, 0x0
    .long 0x0, 0x0, 0x0, 0x0
    .long 0x0, 0x0, 0x0, 0x0
    .long 0x0, 0x0, 0x0, 0x0
    .long 0x0, 0x0, 0x0, 0x0
    .long 0x0, 0x0, 0x0, 0x0
    .long 0x0, 0x0, 0x0, 0x0
    .long 0x0, 0x0, 0x0, 0x0
    .long 0x0, 0x0, 0x0, 0x0
    .long 0x0, 0x0, 0x0, 0x0
    .long 0x3f80, 0x0, 0x0, 0x0
    .long 0x3f803f80, 0x0, 0x0, 0x0
    .long 0x3f803f80, 0x3f80, 0x0, 0x0
    .long 0x3f800000, 0x3f803f80, 0x0, 0x0
    .long 0x0, 0x3f803f80, 0x3f80, 0x0
    .long 0x0, 0x0, 0x0, 0x0
    .long 0x0, 0x0, 0x0, 0x0
    .long 0x0, 0x0, 0x0, 0x0
    .long 0x0, 0x0, 0x0, 0x0
    .long 0x0, 0x0, 0x0, 0x0
    .long 0x0, 0x0, 0x0, 0x0
    .long 0x0, 0x0, 0x0, 0x0
    .long 0x0, 0x0, 0x0, 0x0
    .long 0x0, 0x0, 0x0, 0x0
    .long 0x0, 0x0, 0x0, 0x0
    .long 0x0, 0x0, 0x0, 0x0
    .long 0x0, 0x0, 0x0, 0x0
    .long 0x0, 0x0, 0x0, 0x0
    .long 0x0, 0x0, 0x0, 0x0
    .long 0x0, 0x0, 0x0, 0x0
    .long 0x0, 0x0, 0x0, 0x0
    .long 0x0, 0x0, 0x3f803f80, 0x3f803f80
    .long 0x0, 0x0, 0x3f800000, 0x3f803f80
    .long 0x0, 0x0, 0x0, 0x3f803f80
    .long 0x0, 0x0, 0x0, 0x3f800000
    .long 0x0, 0x0, 0x0, 0x0
    .long 0x0, 0x0, 0x0, 0x0
    .long 0x0, 0x0, 0x0, 0x0
    .long 0x0, 0x0, 0x0, 0x0
    .long 0x0, 0x0, 0x0, 0x0
    .long 0x0, 0x0, 0x0, 0x0
    .long 0x0, 0x0, 0x0, 0x0
    .long 0x0, 0x0, 0x0, 0x0
    .long 0x0, 0x0, 0x0, 0x0
    .long 0x0, 0x0, 0x0, 0x0
    .long 0x0, 0x0, 0x0, 0x0
    .long 0x0, 0x0, 0x0, 0x0
    .long 0x3f803f80, 0x3f803f80, 0x3f80, 0x0
    .long 0x3f803f80, 0x3f803f80, 0x3f803f80, 0x0
    .long 0x3f803f80, 0x3f803f80, 0x3f803f80, 0x3f80
    .long 0x3f803f80, 0x3f803f80, 0x3f803f80, 0x3f803f80
    .long 0x3f803f80, 0x3f803f80, 0x3f803f80, 0x3f803f80
    .long 0x3f800000, 0x3f803f80, 0x3f803f80, 0x3f803f80
    .long 0x0, 0x3f803f80, 0x3f803f80, 0x3f803f80
    .long 0x0, 0x3f800000, 0x3f803f80, 0x3f803f80
    .long 0x0, 0x0, 0x3f803f80, 0x3f803f80
    .long 0x0, 0x0, 0x3f800000, 0x3f803f80
    .long 0x0, 0x0, 0x0, 0x3f803f80
    .long 0x0, 0x0, 0x0, 0x3f800000
    .long 0x0, 0x0, 0x0, 0x0
    .long 0x0, 0x0, 0x0, 0x0
    .long 0x0, 0x0, 0x0, 0x0
    .long 0x0, 0x0, 0x0, 0x0
    .long 0x0, 0x0, 0x0, 0x0
    .long 0x0, 0x0, 0x0, 0x0
    .long 0x0, 0x0, 0x0, 0x0
    .long 0x0, 0x0, 0x0, 0x0
    .long 0x3f80, 0x0, 0x0, 0x0
    .long 0x3f803f80, 0x0, 0x0, 0x0
    .long 0x3f803f80, 0x3f80, 0x0, 0x0
    .long 0x3f803f80, 0x3f803f80, 0x0, 0x0
    .long 0x3f803f80, 0x3f803f80, 0x3f80, 0x0
    .long 0x3f803f80, 0x3f803f80, 0x3f803f80, 0x0
    .long 0x3f803f80, 0x3f803f80, 0x3f803f80, 0x3f80
    .long 0x3f803f80, 0x3f803f80, 0x3f803f80, 0x3f803f80
    .long 0x3f803f80, 0x3f803f80, 0x3f803f80, 0x3f803f80
    .long 0x3f800000, 0x3f803f80, 0x3f803f80, 0x3f803f80
    .long 0x0, 0x3f803f80, 0x3f803f80, 0x3f803f80
    .long 0x0, 0x3f800000, 0x3f803f80, 0x3f803f80
    .long 0x0, 0x0, 0x0, 0x0
    .long 0x0, 0x0, 0x0, 0x0
    .long 0x0, 0x0, 0x0, 0x0
    .long 0x0, 0x0, 0x0, 0x0
    .long 0x0, 0x0, 0x0, 0x0
    .long 0x0, 0x0, 0x0, 0x0
    .long 0x0, 0x0, 0x0, 0x0
    .long 0x0, 0x0, 0x0, 0x0
    .long 0x0, 0x0, 0x0, 0x0
    .long 0x0, 0x0, 0x0, 0x0
    .long 0x0, 0x0, 0x0, 0x0
    .long 0x0, 0x0, 0x0, 0x0
    .long 0x3f80, 0x0, 0x0, 0x0
    .long 0x3f803f80, 0x0, 0x0, 0x0
    .long 0x3f803f80, 0x3f80, 0x0, 0x0
    .long 0x3f803f80, 0x3f803f80, 0x0, 0x0
    .long 0x0, 0x0, 0x3f800000, 0x3f803f80
    .long 0x0, 0x0, 0x0, 0x3f803f80
    .long 0x0, 0x0, 0x0, 0x3f800000
    .long 0x0, 0x0, 0x0, 0x0
    .long 0x0, 0x0, 0x0, 0x0
    .long 0x0, 0x0, 0x0, 0x0
    .long 0x0, 0x0, 0x0, 0x0
    .long 0x0, 0x0, 0x0, 0x0
    .long 0x0, 0x0, 0x0, 0x0
    .long 0x0, 0x0, 0x0, 0x0
    .long 0x0, 0x0, 0x0, 0x0
    .long 0x0, 0x0, 0x0, 0x0
    .long 0x0, 0x0, 0x0, 0x0
    .long 0x0, 0x0, 0x0, 0x0
    .long 0x0, 0x0, 0x0, 0x0
    .long 0x0, 0x0, 0x0, 0x0
    .long 0x3f803f80, 0x3f803f80, 0x0, 0x0
    .long 0x3f803f80, 0x3f803f80, 0x3f80, 0x0
    .long 0x3f803f80, 0x3f803f80, 0x3f803f80, 0x0
    .long 0x3f803f80, 0x3f803f80, 0x3f803f80, 0x3f80
    .long 0x3f800000, 0x3f803f80, 0x3f803f80, 0x3f803f80
    .long 0x0, 0x3f803f80, 0x3f803f80, 0x3f803f80
    .long 0x0, 0x3f800000, 0x3f803f80, 0x3f803f80
    .long 0x0, 0x0, 0x3f803f80, 0x3f803f80
    .long 0x0, 0x0, 0x3f800000, 0x3f803f80
    .long 0x0, 0x0, 0x0, 0x3f803f80
    .long 0x0, 0x0, 0x0, 0x3f800000
    .long 0x0, 0x0, 0x0, 0x0
    .long 0x0, 0x0, 0x0, 0x0
    .long 0x0, 0x0, 0x0, 0x0
    .long 0x0, 0x0, 0x0, 0x0
    .long 0x0, 0x0, 0x0, 0x0
    .long 0x0, 0x0, 0x0, 0x0
    .long 0x0, 0x0, 0x0, 0x0
    .long 0x0, 0x0, 0x0, 0x0
    .long 0x0, 0x0, 0x0, 0x0
    .long 0x0, 0x0, 0x0, 0x0
    .long 0x3f80, 0x0, 0x0, 0x0
    .long 0x3f803f80, 0x0, 0x0, 0x0
    .long 0x3f803f80, 0x3f80, 0x0, 0x0
    .long 0x3f803f80, 0x3f803f80, 0x0, 0x0
    .long 0x3f803f80, 0x3f803f80, 0x3f80, 0x0
    .long 0x3f803f80, 0x3f803f80, 0x3f803f80, 0x0
    .long 0x3f803f80, 0x3f803f80, 0x3f803f80, 0x3f80
    .long 0x3f800000, 0x3f803f80, 0x3f803f80, 0x3f803f80
    .long 0x0, 0x3f803f80, 0x3f803f80, 0x3f803f80
    .long 0x0, 0x3f800000, 0x3f803f80, 0x3f803f80
    .long 0x0, 0x0, 0x3f803f80, 0x3f803f80
    .long 0x0, 0x0, 0x0, 0x0
    .long 0x0, 0x0, 0x0, 0x0
    .long 0x0, 0x0, 0x0, 0x0
    .long 0x0, 0x0, 0x0, 0x0
    .long 0x0, 0x0, 0x0, 0x0
    .long 0x0, 0x0, 0x0, 0x0
    .long 0x0, 0x0, 0x0, 0x0
    .long 0x0, 0x0, 0x0, 0x0
    .long 0x0, 0x0, 0x0, 0x0
    .long 0x0, 0x0, 0x0, 0x0
    .long 0x0, 0x0, 0x0, 0x0
    .long 0x0, 0x0, 0x0, 0x0
    .long 0x0, 0x0, 0x0, 0x0
    .long 0x3f80, 0x0, 0x0, 0x0
    .long 0x3f803f80, 0x0, 0x0, 0x0
    .long 0x3f803f80, 0x3f80, 0x0, 0x0
    .long 0x10200, 0x0, 0x1f560, 0x1fb9c
    .long 0x10a10, 0x810, 0x1f570, 0x1fde0
    .long 0x11220, 0x1020, 0x1f580, 0x1faa4
    .long 0x11a30, 0x1830, 0x1f590, 0x1faa8
    .long 0x162c0, 0x2040, 0x1f5a0, 0x1faac
    .long 0x16ad0, 0x2850, 0x1f5b0, 0x1fab0
    .long 0x172e0, 0x3060, 0x1f5c0, 0x1fab4
    .long 0x17af0, 0x3870, 0x1f5d0, 0x1fab8
    .long 0x18300, 0x4080, 0x1f5e0, 0x1fabc
    .long 0x18b10, 0x4890, 0x1f5f0, 0x1fac0
    .long 0x13260, 0x50a0, 0x1f600, 0x1fac4
    .long 0x13260, 0x58b0, 0x1f610, 0x1fac8
    .long 0x13260, 0x60c0, 0x1f620, 0x1facc
    .long 0x12240, 0x68d0, 0x1f630, 0x1fad0
    .long 0x12a50, 0x70e0, 0x1f640, 0x1fad4
    .long 0x12a50, 0x78f0, 0x1f650, 0x1fad8
    .long 0x19320, 0x8100, 0x1f660, 0x1fadc
    .long 0x19b30, 0x8910, 0x1f670, 0x1fae0
    .long 0x1a340, 0x9120, 0x1f680, 0x1fae4
    .long 0x1ab50, 0x9930, 0x1f690, 0x1fae8
    .long 0x14280, 0xa140, 0x1f6a0, 0x1faec
    .long 0x14a90, 0xa950, 0x1f6b0, 0x1faf0
    .long 0x152a0, 0xb160, 0x1f6c0, 0x1faf4
    .long 0x15ab0, 0xb970, 0x1f6d0, 0x1faf8
    .long 0x13a70, 0xc180, 0x1f6e0, 0x1fafc
    .long 0x13a70, 0xc990, 0x1f6f0, 0x1fb00
    .long 0x13a70, 0xd1a0, 0x1f700, 0x1fb04
    .long 0x13a70, 0xd9b0, 0x1f710, 0x1fb08
    .long 0x13a70, 0xe1c0, 0x1f720, 0x1fb0c
    .long 0x13a70, 0xe9d0, 0x1f730, 0x1fb10
    .long 0x13a70, 0xf1e0, 0x1f740, 0x1fb14
    .long 0x13a70, 0xf9f0, 0x1f750, 0x1fb18
    .long 0x10210, 0x10, 0x1f568, 0x1fb1c
    .long 0x10a20, 0x820, 0x1f578, 0x1fb20
    .long 0x11230, 0x1030, 0x1f588, 0x1fb24
    .long 0x11a40, 0x1840, 0x1f598, 0x1fb28
    .long 0x162d0, 0x2050, 0x1f5a8, 0x1fb2c
    .long 0x16ae0, 0x2860, 0x1f5b8, 0x1fb30
    .long 0x172f0, 0x3070, 0x1f5c8, 0x1fb34
    .long 0x17b00, 0x3880, 0x1f5d8, 0x1fb38
    .long 0x18310, 0x4090, 0x1f5e8, 0x1fb3c
    .long 0x18b20, 0x48a0, 0x1f5f8, 0x1fb40
    .long 0x13270, 0x50b0, 0x1f608, 0x1fb44
    .long 0x13270, 0x58c0, 0x1f618, 0x1fb48
    .long 0x13270, 0x60d0, 0x1f628, 0x1fb4c
    .long 0x12250, 0x68e0, 0x1f638, 0x1fb50
    .long 0x12a60, 0x70f0, 0x1f648, 0x1fb54
    .long 0x12a60, 0x7900, 0x1f658, 0x1fb58
    .long 0x19330, 0x8110, 0x1f668, 0x1fb5c
    .long 0x19b40, 0x8920, 0x1f678, 0x1fb60
    .long 0x1a350, 0x9130, 0x1f688, 0x1fb64
    .long 0x1ab60, 0x9940, 0x1f698, 0x1fb68
    .long 0x14290, 0xa150, 0x1f6a8, 0x1fb6c
    .long 0x14aa0, 0xa960, 0x1f6b8, 0x1fb70
    .long 0x152b0, 0xb170, 0x1f6c8, 0x1fb74
    .long 0x15ac0, 0xb980, 0x1f6d8, 0x1fb78
    .long 0x13a80, 0xc190, 0x1f6e8, 0x1fb7c
    .long 0x13a80, 0xc9a0, 0x1f6f8, 0x1fb80
    .long 0x13a80, 0xd1b0, 0x1f708, 0x1fb84
    .long 0x13a80, 0xd9c0, 0x1f718, 0x1fb88
    .long 0x13a80, 0xe1d0, 0x1f728, 0x1fb8c
    .long 0x13a80, 0xe9e0, 0x1f738, 0x1fb90
    .long 0x13a80, 0xf1f0, 0x1f748, 0x1fb94
    .long 0x13a80, 0xfa00, 0x1f758, 0x1fb98
    .long 0x1fd20, 0x10000, 0x1f960, 0x0
    .long 0x1fd1e, 0x10010, 0x1f970, 0x10
    .long 0x1fd1c, 0x10020, 0x14020, 0x20
    .long 0x1fd1a, 0x10030, 0x14030, 0x30
    .long 0x1fd18, 0x10040, 0x14040, 0x40
    .long 0x1fd16, 0x10050, 0x14050, 0x50
    .long 0x1fd14, 0x10060, 0x14060, 0x60
    .long 0x1fd12, 0x10070, 0x14070, 0x70
    .long 0x1fd10, 0x10080, 0x14080, 0x200
    .long 0x1fd0e, 0x10090, 0x14090, 0x210
    .long 0x1fd0c, 0x100a0, 0x140a0, 0x220
    .long 0x1fd0a, 0x100b0, 0x140b0, 0x230
    .long 0x1fd08, 0x100c0, 0x140c0, 0x240
    .long 0x1fd06, 0x100d0, 0x140d0, 0x250
    .long 0x1fd04, 0x100e0, 0x140e0, 0x260
    .long 0x1fd02, 0x100f0, 0x140f0, 0x270
    .long 0x1fd00, 0x10100, 0x14100, 0x80
    .long 0x1fcfe, 0x10110, 0x14110, 0x90
    .long 0x1fcfc, 0x10120, 0x14120, 0xa0
    .long 0x1fcfa, 0x10130, 0x14130, 0xb0
    .long 0x1fcf8, 0x10140, 0x14140, 0xc0
    .long 0x1fcf6, 0x10150, 0x14150, 0xd0
    .long 0x1fcf4, 0x10160, 0x14160, 0xe0
    .long 0x1fcf2, 0x10170, 0x14170, 0xf0
    .long 0x1fcf0, 0x10180, 0x14180, 0x280
    .long 0x1fcee, 0x10190, 0x14190, 0x290
    .long 0x1fcec, 0x101a0, 0x141a0, 0x2a0
    .long 0x1fcea, 0x101b0, 0x141b0, 0x2b0
    .long 0x1fce8, 0x101c0, 0x141c0, 0x2c0
    .long 0x1fce6, 0x101d0, 0x141d0, 0x2d0
    .long 0x1fce4, 0x101e0, 0x141e0, 0x2e0
    .long 0x1fce2, 0x101f0, 0x141f0, 0x2f0
    .long 0x1fca0, 0x10200, 0x14200, 0x100
    .long 0x1fc9e, 0x10210, 0x14210, 0x110
    .long 0x1fc9c, 0x10220, 0x14220, 0x120
    .long 0x1fc9a, 0x10230, 0x14230, 0x130
    .long 0x1fc98, 0x10240, 0x14240, 0x140
    .long 0x1fc96, 0x10250, 0x14250, 0x150
    .long 0x1fc94, 0x10260, 0x14260, 0x160
    .long 0x1fc92, 0x10270, 0x14270, 0x170
    .long 0x1fc90, 0x10280, 0x14280, 0x300
    .long 0x1fc8e, 0x10290, 0x14290, 0x310
    .long 0x1fc8c, 0x102a0, 0x142a0, 0x320
    .long 0x1fc8a, 0x102b0, 0x142b0, 0x330
    .long 0x1fc88, 0x102c0, 0x142c0, 0x340
    .long 0x1fc86, 0x102d0, 0x142d0, 0x350
    .long 0x1fc84, 0x102e0, 0x142e0, 0x360
    .long 0x1fc82, 0x102f0, 0x142f0, 0x370
    .long 0x1fc80, 0x10300, 0x14300, 0x180
    .long 0x1fc7e, 0x10310, 0x14310, 0x190
    .long 0x1fc7c, 0x10320, 0x14320, 0x1a0
    .long 0x1fc7a, 0x10330, 0x14330, 0x1b0
    .long 0x1fc78, 0x10340, 0x14340, 0x1c0
    .long 0x1fc76, 0x10350, 0x14350, 0x1d0
    .long 0x1fc74, 0x10360, 0x14360, 0x1e0
    .long 0x1fc72, 0x10370, 0x14370, 0x1f0
    .long 0x1fc70, 0x10380, 0x14380, 0x380
    .long 0x1fc6e, 0x10390, 0x14390, 0x390
    .long 0x1fc6c, 0x103a0, 0x143a0, 0x3a0
    .long 0x1fc6a, 0x103b0, 0x143b0, 0x3b0
    .long 0x1fc68, 0x103c0, 0x143c0, 0x3c0
    .long 0x1fc66, 0x103d0, 0x143d0, 0x3d0
    .long 0x1fc64, 0x103e0, 0x143e0, 0x3e0
    .long 0x1fc62, 0x1fc60, 0x143f0, 0x3f0
    .long 0x1b480, 0x1b390, 0x1f530, 0x1fa68
    .long 0x1b470, 0x1b3b0, 0x1f550, 0x1fa70
    .long 0x1b460, 0x1b3d0, 0x1f570, 0x1fa78
    .long 0x1b450, 0x1b3f0, 0x1f590, 0x1fa80
    .long 0x1b440, 0x1b410, 0x1f5b0, 0x1fa88
    .long 0x1b430, 0x1b430, 0x1f5d0, 0x1fa90
    .long 0x1b420, 0x1b450, 0x1f5f0, 0x1fa98
    .long 0x1b410, 0x1b470, 0x1f610, 0x1faa0
    .long 0x1b400, 0x1b490, 0x1ff30, 0x204e8
    .long 0x1b3f0, 0x1b4b0, 0x1ff50, 0x204f0
    .long 0x1b3e0, 0x1b4d0, 0x1ff70, 0x204f8
    .long 0x1b3d0, 0x1b4f0, 0x1ff90, 0x20500
    .long 0x1b3c0, 0x1b510, 0x1ffb0, 0x20508
    .long 0x1b3b0, 0x1b530, 0x1ffd0, 0x20510
    .long 0x1b3a0, 0x1b550, 0x1fff0, 0x20518
    .long 0x1b390, 0x1b570, 0x20010, 0x20520
    .long 0x1b490, 0x1b3a0, 0x1f520, 0x1fa78
    .long 0x1b480, 0x1b3c0, 0x1f540, 0x1fa80
    .long 0x1b470, 0x1b3e0, 0x1f560, 0x1fa88
    .long 0x1b460, 0x1b400, 0x1f580, 0x1fa90
    .long 0x1b450, 0x1b420, 0x1f5a0, 0x1fa98
    .long 0x1b440, 0x1b440, 0x1f5c0, 0x1faa0
    .long 0x1b430, 0x1b460, 0x1f5e0, 0x1faa8
    .long 0x1b420, 0x1b480, 0x1f600, 0x1fab0
    .long 0x1b410, 0x1b4a0, 0x1ff20, 0x204f8
    .long 0x1b400, 0x1b4c0, 0x1ff40, 0x20500
    .long 0x1b3f0, 0x1b4e0, 0x1ff60, 0x20508
    .long 0x1b3e0, 0x1b500, 0x1ff80, 0x20510
    .long 0x1b3d0, 0x1b520, 0x1ffa0, 0x20518
    .long 0x1b3c0, 0x1b540, 0x1ffc0, 0x20520
    .long 0x1b3b0, 0x1b560, 0x1ffe0, 0x20528
    .long 0x1b3a0, 0x1b580, 0x20000, 0x20530
    .long 0x1b4a0, 0x1b3b0, 0x1f510, 0x1fa88
    .long 0x1b490, 0x1b3d0, 0x1f530, 0x1fa90
    .long 0x1b480, 0x1b3f0, 0x1f550, 0x1fa98
    .long 0x1b470, 0x1b410, 0x1f570, 0x1faa0
    .long 0x1b460, 0x1b430, 0x1f590, 0x1faa8
    .long 0x1b450, 0x1b450, 0x1f5b0, 0x1fab0
    .long 0x1b440, 0x1b470, 0x1f5d0, 0x1fab8
    .long 0x1b430, 0x1b490, 0x1f5f0, 0x1fac0
    .long 0x1b420, 0x1b4b0, 0x1ff10, 0x20508
    .long 0x1b410, 0x1b4d0, 0x1ff30, 0x20510
    .long 0x1b400, 0x1b4f0, 0x1ff50, 0x20518
    .long 0x1b3f0, 0x1b510, 0x1ff70, 0x20520
    .long 0x1b3e0, 0x1b530, 0x1ff90, 0x20528
    .long 0x1b3d0, 0x1b550, 0x1ffb0, 0x20530
    .long 0x1b3c0, 0x1b570, 0x1ffd0, 0x20538
    .long 0x1b3b0, 0x1b590, 0x1fff0, 0x20540
    .long 0x1b4b0, 0x1b3c0, 0x1f500, 0x1fa98
    .long 0x1b4a0, 0x1b3e0, 0x1f520, 0x1faa0
    .long 0x1b490, 0x1b400, 0x1f540, 0x1faa8
    .long 0x1b480, 0x1b420, 0x1f560, 0x1fab0
    .long 0x1b470, 0x1b440, 0x1f580, 0x1fab8
    .long 0x1b460, 0x1b460, 0x1f5a0, 0x1fac0
    .long 0x1b450, 0x1b480, 0x1f5c0, 0x1fac8
    .long 0x1b440, 0x1b4a0, 0x1f5e0, 0x1fad0
    .long 0x1b430, 0x1b4c0, 0x1ff00, 0x20518
    .long 0x1b420, 0x1b4e0, 0x1ff20, 0x20520
    .long 0x1b410, 0x1b500, 0x1ff40, 0x20528
    .long 0x1b400, 0x1b520, 0x1ff60, 0x20530
    .long 0x1b3f0, 0x1b540, 0x1ff80, 0x20538
    .long 0x1b3e0, 0x1b560, 0x1ffa0, 0x20540
    .long 0x1b3d0, 0x1b580, 0x1ffc0, 0x20548
    .long 0x1b3c0, 0x1b5a0, 0x1ffe0, 0x20550
    .long 0x1fc7c, 0x1c3e0, 0x0, 0x0
    .long 0x1fc78, 0x1b3a4, 0x0, 0x0
    .long 0x1fc74, 0x1c3e4, 0x0, 0x0
    .long 0x1fc70, 0x1b3a8, 0x0, 0x0
    .long 0x1fc6c, 0x1c3e8, 0x0, 0x0
    .long 0x1fc68, 0x1b3ac, 0x0, 0x0
    .long 0x1fc64, 0x1c3ec, 0x0, 0x0
    .long 0x1fc60, 0x1b3b0, 0x0, 0x0
    .long 0x206bc, 0x1c3f0, 0x0, 0x0
    .long 0x206b8, 0x1b3b4, 0x0, 0x0
    .long 0x206b4, 0x1c3f4, 0x0, 0x0
    .long 0x206b0, 0x1b3b8, 0x0, 0x0
    .long 0x206ac, 0x1c3f8, 0x0, 0x0
    .long 0x206a8, 0x1b3bc, 0x0, 0x0
    .long 0x206a4, 0x1c3fc, 0x0, 0x0
    .long 0x206a0, 0x1b3c0, 0x0, 0x0
    .long 0x1fc8c, 0x1c3f0, 0x0, 0x0
    .long 0x1fc88, 0x1b3b4, 0x0, 0x0
    .long 0x1fc84, 0x1c3f4, 0x0, 0x0
    .long 0x1fc80, 0x1b3b8, 0x0, 0x0
    .long 0x1fc7c, 0x1c3f8, 0x0, 0x0
    .long 0x1fc78, 0x1b3bc, 0x0, 0x0
    .long 0x1fc74, 0x1c3fc, 0x0, 0x0
    .long 0x1fc70, 0x1b3c0, 0x0, 0x0
    .long 0x206cc, 0x1c400, 0x0, 0x0
    .long 0x206c8, 0x1b3c4, 0x0, 0x0
    .long 0x206c4, 0x1c404, 0x0, 0x0
    .long 0x206c0, 0x1b3c8, 0x0, 0x0
    .long 0x206bc, 0x1c408, 0x0, 0x0
    .long 0x206b8, 0x1b3cc, 0x0, 0x0
    .long 0x206b4, 0x1c40c, 0x0, 0x0
    .long 0x206b0, 0x1b3d0, 0x0, 0x0
    .long 0x1fc9c, 0x1c400, 0x0, 0x0
    .long 0x1fc98, 0x1b3c4, 0x0, 0x0
    .long 0x1fc94, 0x1c404, 0x0, 0x0
    .long 0x1fc90, 0x1b3c8, 0x0, 0x0
    .long 0x1fc8c, 0x1c408, 0x0, 0x0
    .long 0x1fc88, 0x1b3cc, 0x0, 0x0
    .long 0x1fc84, 0x1c40c, 0x0, 0x0
    .long 0x1fc80, 0x1b3d0, 0x0, 0x0
    .long 0x206dc, 0x1c410, 0x0, 0x0
    .long 0x206d8, 0x1b3d4, 0x0, 0x0
    .long 0x206d4, 0x1c414, 0x0, 0x0
    .long 0x206d0, 0x1b3d8, 0x0, 0x0
    .long 0x206cc, 0x1c418, 0x0, 0x0
    .long 0x206c8, 0x1b3dc, 0x0, 0x0
    .long 0x206c4, 0x1c41c, 0x0, 0x0
    .long 0x206c0, 0x1b3e0, 0x0, 0x0
    .long 0x1fcac, 0x1c410, 0x0, 0x0
    .long 0x1fca8, 0x1b3d4, 0x0, 0x0
    .long 0x1fca4, 0x1c414, 0x0, 0x0
    .long 0x1fca0, 0x1b3d8, 0x0, 0x0
    .long 0x1fc9c, 0x1c418, 0x0, 0x0
    .long 0x1fc98, 0x1b3dc, 0x0, 0x0
    .long 0x1fc94, 0x1c41c, 0x0, 0x0
    .long 0x1fc90, 0x1b3e0, 0x0, 0x0
    .long 0x206ec, 0x1c420, 0x0, 0x0
    .long 0x206e8, 0x1b3e4, 0x0, 0x0
    .long 0x206e4, 0x1c424, 0x0, 0x0
    .long 0x206e0, 0x1b3e8, 0x0, 0x0
    .long 0x206dc, 0x1c428, 0x0, 0x0
    .long 0x206d8, 0x1b3ec, 0x0, 0x0
    .long 0x206d4, 0x1c42c, 0x0, 0x0
    .long 0x206d0, 0x1b3f0, 0x0, 0x0
.section .rodata,"a"
.p2align 6
.amdhsa_kernel gated_mix__ssm_conv_s4d__ssm_conv_s4d__prompt_kernel
  .amdhsa_next_free_vgpr 256
  .amdhsa_next_free_sgpr 102
  .amdhsa_accum_offset 128
  .amdhsa_group_segment_fixed_size 0
  .amdhsa_kernarg_size 144
  .amdhsa_user_sgpr_count 2
  .amdhsa_user_sgpr_kernarg_segment_ptr 1
  .amdhsa_system_sgpr_workgroup_id_x 1
.end_amdhsa_kernel
```
